```python
import torch

def _softmax(x, axis=-1):
    return torch.softmax(x, dim=axis)
def _gelu(x):
    return torch.nn.functional.gelu(x, approximate="tanh")
def _silu(x):
    return torch.nn.functional.silu(x)
def _sigmoid(x):
    return torch.sigmoid(x)
def _layernorm(x, axis=-1, eps=1e-5):
    m = x.mean(dim=axis, keepdim=True)
    v = x.var(dim=axis, keepdim=True, unbiased=False)
    return (x - m) / torch.sqrt(v + eps)
def _scatter_add(tgt, idx, src, axis=0):
    return tgt.clone().index_add_(axis, idx, src)
def _segment_sum(src, seg, n):
    out = torch.zeros((n,) + src.shape[1:], dtype=src.dtype)
    return out.index_add_(0, seg, src)
def _pad(x, pw):
    flat = tuple(v for pair in reversed(pw) for v in pair)
    return torch.nn.functional.pad(x, flat)

kernel_name = 'sequential_preLN__sliding_block_cached__swiglu_ffn__decode'

def setup_inputs():

    _w = (lambda a: (lambda t: t.to(torch.bfloat16) if t.is_floating_point() else t)(torch.as_tensor(a)))
    def _A_setup():
        B, Sq, D = 1, 1, 512
        Hq, Hkv, Sk, Dh = 32, 8, 65536, 128
        assert Hq % Hkv == 0, (Hq, Hkv)
        return {
            "x": _w((lambda *s: torch.randn(*s, dtype=torch.bfloat16) * 0.05)(B, Sq, D)),
            "k_cache": _w((lambda *s: torch.randn(*s, dtype=torch.bfloat16) * 3.2)(B, Hkv, Sk, Dh)),
            "v_cache": _w((lambda *s: torch.randn(*s, dtype=torch.bfloat16) * 0.4)(B, Hkv, Sk, Dh)),
            "wq": _w((lambda *s: torch.randn(*s, dtype=torch.bfloat16) * 3.2)(D, Hq * Dh) * (D ** -0.5)),
            "wo": _w((lambda *s: torch.randn(*s, dtype=torch.bfloat16) * 0.4)(Hq * Dh, D) * ((Hq * Dh) ** -0.5)),
        }
    _A_in = _A_setup()

    def _B_setup():
        B, S, D, F = 1, 1, 512, 1792
        return {
            "x": _w((lambda *s: torch.randn(*s, dtype=torch.bfloat16) * 0.05)(B, S, D)),
            "w_gate": _w((lambda *s: torch.randn(*s, dtype=torch.bfloat16) * 0.05)(D, F)),
            "w_up": _w((lambda *s: torch.randn(*s, dtype=torch.bfloat16) * 0.05)(D, F)),
            "w_down": _w((lambda *s: torch.randn(*s, dtype=torch.bfloat16) * 0.05)(F, D)),
        }
    _B_in = _B_setup()

    return {
        "A_x": _A_in["x"],
        "A_k_cache": _A_in["k_cache"],
        "A_v_cache": _A_in["v_cache"],
        "A_wq": _A_in["wq"],
        "A_wo": _A_in["wo"],
        "B_x": _B_in["x"],
        "B_w_gate": _B_in["w_gate"],
        "B_w_up": _B_in["w_up"],
        "B_w_down": _B_in["w_down"],
    }

def reference(A_x, A_k_cache, A_v_cache, A_wq, A_wo, B_x, B_w_gate, B_w_up, B_w_down):
    def _A_ref(x, k_cache, v_cache, wq, wo):
        B, Sq, D = x.shape
        Hq, Dh = 32, 128
        Hkv, Sk = k_cache.shape[1], k_cache.shape[2]
        W = min(4096, max(256, Sk // 4))
        rep = Hq // Hkv
        q = (lambda x, *d: x.permute(*d))((x @ wq).reshape(B, Sq, Hq, Dh), 0, 2, 1, 3)
        k = (lambda x, n, axis: torch.repeat_interleave(x, n, dim=axis))(k_cache[:, :, Sk - W:, :], rep, axis=1)
        v = (lambda x, n, axis: torch.repeat_interleave(x, n, dim=axis))(v_cache[:, :, Sk - W:, :], rep, axis=1)
        scores = torch.einsum("bhqd,bhkd->bhqk", q, k) * (Dh ** -0.5)
        p = _softmax(scores, axis=-1)
        o = torch.einsum("bhqk,bhkd->bhqd", p, v)
        return (lambda x, *d: x.permute(*d))(o, 0, 2, 1, 3).reshape(B, Sq, Hq * Dh) @ wo

    def _B_ref(x, w_gate, w_up, w_down):
        g = _silu(x @ w_gate)
        u = x @ w_up
        return (g * u) @ w_down

    x = A_x
    h = x + _A_ref(_layernorm(x, axis=-1), A_k_cache, A_v_cache, A_wq, A_wo)
    h2 = h + _B_ref(_layernorm(h, axis=-1), B_w_gate, B_w_up, B_w_down)
    return h2
```

```asm
; @launch grid=(256,1,1) block=(320,1,1) lds=65536
.amdgcn_target "amdgcn-amd-amdhsa--gfx950"
.text
.globl sequential_preLN__sliding_block_cached__swiglu_ffn__decode_kernel
.p2align 8
.type sequential_preLN__sliding_block_cached__swiglu_ffn__decode_kernel,@function
sequential_preLN__sliding_block_cached__swiglu_ffn__decode_kernel:
  s_cmpk_ge_u32 s2, 0x100
  s_cbranch_scc1 L_end
  s_load_dwordx16 s[4:19], s[0:1], 0
  s_load_dwordx8 s[20:27], s[0:1], 64
  v_lshrrev_b32 v12, 6, v0
  v_and_b32 v0, 63, v0
  v_readfirstlane_b32 s3, v12
  s_and_b32 s28, s2, 7
  s_lshr_b32 s29, s2, 3
  v_and_b32 v3, 15, v0
  v_lshrrev_b32 v4, 4, v0
  s_lshl_b32 s54, s28, 24
  s_and_b32 s55, s29, 15
  s_lshl_b32 s55, s55, 12
  s_add_u32 s54, s54, s55
  s_lshl_b32 s55, s3, 10
  s_add_u32 s54, s54, s55
  s_cmp_lt_u32 s29, 16
  s_cselect_b32 s55, 786432, 0
  s_add_u32 s54, s54, s55
  s_add_u32 s54, s54, 0xF00000
  v_xor_b32 v12, v3, v4
  v_lshlrev_b32 v12, 4, v12
  v_lshl_add_u32 v12, v4, 8, v12
  v_add_u32 v228, s54, v12
  v_xor_b32 v229, 73792, v228
  v_xor_b32 v230, 131200, v228
  v_xor_b32 v231, 204992, v228
  v_lshlrev_b32 v2, 16, v4
  v_lshl_add_u32 v2, v3, 4, v2
  v_add_u32 v2, s54, v2
  v_lshlrev_b32 v12, 9, v0
  v_and_b32 v12, 0x2000, v12
  v_xor_b32 v2, v12, v2
  s_cmp_eq_u32 s3, 4
  s_cbranch_scc1 L_helper
  s_cmp_lt_u32 s29, 16
  s_cbranch_scc1 L_l_start
  s_mul_i32 s57, s3, 12288
  s_waitcnt lgkmcnt(0)
  s_add_u32 m0, s57, 16384
  s_nop 0
  global_load_lds_dwordx4 v228, s[6:7] nt
  s_add_u32 m0, s57, 17408
  s_nop 0
  global_load_lds_dwordx4 v229, s[6:7] nt
  s_add_u32 m0, s57, 18432
  s_nop 0
  global_load_lds_dwordx4 v230, s[6:7] nt
  s_add_u32 m0, s57, 19456
  s_nop 0
  global_load_lds_dwordx4 v231, s[6:7] nt
  s_add_u32 s0, s6, 262144
  s_addc_u32 s1, s7, 0
  s_add_u32 s14, s6, 524288
  s_addc_u32 s15, s7, 0
  s_add_u32 m0, s57, 20480
  s_nop 0
  global_load_lds_dwordx4 v228, s[0:1] nt
  s_add_u32 m0, s57, 21504
  s_nop 0
  global_load_lds_dwordx4 v229, s[0:1] nt
  s_add_u32 m0, s57, 22528
  s_nop 0
  global_load_lds_dwordx4 v230, s[0:1] nt
  s_add_u32 m0, s57, 23552
  s_nop 0
  global_load_lds_dwordx4 v231, s[0:1] nt
  s_load_dword s30, s[26:27], 0
  s_branch L_h_rest
L_l_start:
  v_lshlrev_b32 v12, 4, v0
  v_lshrrev_b32 v14, 3, v0
  s_and_b32 s56, s29, 1
  s_lshl_b32 s56, s56, 2
  s_add_u32 s56, s56, s3
  s_lshl_b32 s54, s56, 7
  v_lshl_add_u32 v13, v14, 4, s54
  s_lshl_b32 s54, s56, 19
  s_lshl_b32 s55, s28, 10
  s_add_u32 s54, s54, s55
  s_bfe_u32 s55, s29, 0x30001
  s_lshl_b32 s55, s55, 7
  s_add_u32 s54, s54, s55
  v_lshlrev_b32 v14, 16, v14
  v_and_b32 v15, 7, v0
  v_lshl_add_u32 v14, v15, 4, v14
  v_add_u32 v14, s54, v14
  v_and_b32 v15, 1, v0
  v_lshlrev_b32 v10, 4, v15
  v_lshl_add_u32 v10, v4, 2, v10
  v_bfe_u32 v15, v0, 1, 2
  v_add_u32 v10, v15, v10
  s_lshl_b32 s54, s29, 6
  v_lshl_add_u32 v15, v10, 1, s54
  s_waitcnt lgkmcnt(0)
  global_load_dwordx4 v[176:179], v12, s[4:5]
  global_load_dwordx4 v[180:183], v13, s[4:5]
  global_load_ushort v11, v15, s[4:5]
  global_load_dwordx4 v[96:99], v14, s[10:11] nt
  v_add_u32 v14, 0x2000, v14
  global_load_dwordx4 v[100:103], v14, s[10:11] nt
  v_add_u32 v14, 0x2000, v14
  global_load_dwordx4 v[104:107], v14, s[10:11] nt
  v_add_u32 v14, 0x2000, v14
  global_load_dwordx4 v[108:111], v14, s[10:11] nt
  v_add_u32 v14, 0x2000, v14
  global_load_dwordx4 v[112:115], v14, s[10:11] nt
  v_add_u32 v14, 0x2000, v14
  global_load_dwordx4 v[116:119], v14, s[10:11] nt
  v_add_u32 v14, 0x2000, v14
  global_load_dwordx4 v[120:123], v14, s[10:11] nt
  v_add_u32 v14, 0x2000, v14
  global_load_dwordx4 v[124:127], v14, s[10:11] nt
  s_load_dword s30, s[26:27], 0
  s_branch L_l_rest
L_l_rest:
  s_barrier
  s_mov_b32 s38, 0x0c0c0400
  s_mov_b32 s39, 0x04000c0c
  s_mov_b32 s40, 0x05040100
  s_mov_b32 s41, 0x07060302
  s_mov_b32 s50, 0xffff0000
  s_mov_b32 s51, 0xffff0000
  s_mov_b32 s60, 0x20000
  s_mov_b32 s59, 0
  s_mov_b32 s24, 2
  v_mov_b32 v5, 0x07060500
  s_getreg_b32 s31, hwreg(HW_REG_XCC_ID, 0, 4)
  s_lshl_b32 s54, s28, 7
  s_add_u32 s54, s54, 4096
  v_lshl_add_u32 v237, v3, 2, s54
  s_lshl_b32 s54, s28, 13
  s_lshl_b32 s55, s3, 10
  s_add_u32 s54, s54, s55
  s_add_u32 s54, s54, 854016
  v_lshl_add_u32 v6, v0, 4, s54
  s_mov_b64 s[52:53], s[26:27]
  v_xor_b32 v12, v3, v4
  v_lshlrev_b32 v12, 4, v12
  v_lshl_add_u32 v12, v3, 8, v12
  s_mul_i32 s54, s3, 4096
  v_add_u32 v238, s54, v12
  s_lshl_b32 s54, s3, 8
  v_lshl_add_u32 v239, v0, 2, s54
  v_lshrrev_b32 v12, 2, v3
  v_lshlrev_b32 v13, 8, v12
  v_lshl_add_u32 v240, v4, 4, v13
  s_lshl_b32 s55, s3, 3
  v_lshl_add_u32 v241, v12, 5, s55
  s_mul_i32 s55, s3, 2176
  s_add_u32 s55, s55, 4096
  v_lshl_add_u32 v242, v0, 2, s55
  v_add_u32 v253, 1088, v242
  s_lshl_b32 s55, s3, 5
  v_mov_b32 v254, s55
  s_lshl_b32 s55, s3, 6
  s_add_u32 s55, s55, 4096
  v_and_b32 v12, 0x3c, v0
  v_add_u32 v243, s55, v12
  v_and_b32 v12, 3, v0
  v_mul_u32_u24 v12, 544, v12
  v_add_u32 v243, v12, v243
  v_add_u32 v205, 2176, v243
  v_add_u32 v206, 4352, v243
  v_add_u32 v207, 6528, v243
  s_lshl_b32 s54, s28, 16
  s_lshl_b32 s55, s29, 11
  s_add_u32 s54, s54, s55
  s_lshl_b32 s55, s3, 9
  s_add_u32 s54, s54, s55
  s_add_u32 s54, s54, 65536
  v_lshl_add_u32 v244, v0, 3, s54
  s_lshl_b32 s54, s28, 11
  s_lshl_b32 s55, s29, 6
  s_add_u32 s54, s54, s55
  s_lshl_b32 s55, s3, 4
  s_add_u32 s54, s54, s55
  s_add_u32 s54, s54, 8192
  v_mov_b32 v245, s54
  s_lshl_b32 s54, s28, 19
  s_lshl_b32 s55, s29, 15
  s_add_u32 s54, s54, s55
  s_lshl_b32 s55, s3, 8
  s_add_u32 s54, s54, s55
  s_add_u32 s54, s54, 4096
  v_lshlrev_b32 v12, 13, v4
  v_lshl_add_u32 v12, v3, 4, v12
  v_add_u32 v128, s54, v12
  v_lshrrev_b32 v12, 1, v0
  s_lshl_b32 s54, s28, 11
  s_lshr_b32 s55, s29, 2
  s_lshl_b32 s55, s55, 4
  s_add_u32 s54, s54, s55
  s_add_u32 s54, s54, 8192
  v_lshl_add_u32 v129, v12, 6, s54
  s_lshl_b32 s58, s28, 16
  s_add_u32 s58, s58, 65536
  s_lshl_b32 s55, s29, 7
  s_add_u32 s56, s58, s55
  s_lshl_b32 s55, s3, 5
  s_add_u32 s54, s56, s55
  v_lshlrev_b32 v130, 11, v12
  v_and_b32 v13, 1, v0
  v_lshl_add_u32 v130, v13, 4, v130
  v_add_u32 v130, s54, v130
  v_lshlrev_b32 v131, 3, v13
  v_lshl_add_u32 v131, v4, 1, v131
  s_lshl_b32 s55, s3, 4
  v_add_u32 v131, s55, v131
  v_lshlrev_b32 v132, 4, v4
  v_lshrrev_b32 v12, 2, v3
  v_lshlrev_b32 v133, 11, v12
  v_and_b32 v12, 3, v3
  v_lshl_add_u32 v133, v12, 5, v133
  v_and_b32 v12, 1, v4
  v_lshl_add_u32 v133, v12, 4, v133
  s_lshl_b32 s55, s3, 13
  s_add_u32 s54, s56, s55
  v_add_u32 v133, s54, v133
  s_add_u32 s56, s56, 32768
  v_lshl_add_u32 v137, v10, 2, s56
  v_lshlrev_b32 v138, 2, v10
  s_lshl_b32 s55, s29, 11
  s_add_u32 s54, s58, s55
  v_lshl_add_u32 v134, v0, 4, s54
  v_and_b32 v12, 7, v0
  v_lshlrev_b32 v135, 2, v12
  v_lshl_add_u32 v135, v4, 5, v135
  v_bfe_u32 v13, v0, 3, 1
  v_lshl_add_u32 v135, v13, 13, v135
  s_and_b32 s54, s28, 4
  s_add_u32 s54, s54, s28
  s_lshl_b32 s54, s54, 11
  s_lshl_b32 s55, s29, 7
  s_add_u32 s55, s55, 32768
  s_add_u32 s54, s54, s55
  v_add_u32 v135, s54, v135
  v_lshrrev_b32 v136, 3, v0
  v_and_b32 v13, 4, v136
  v_add_u32 v136, v13, v136
  v_lshlrev_b32 v136, 11, v136
  v_lshl_add_u32 v136, v12, 4, v136
  s_lshr_b32 s54, s28, 2
  s_mul_i32 s54, s54, 8192
  s_add_u32 s55, s55, s54
  v_add_u32 v136, s55, v136
  s_lshl_b32 s54, s28, 9
  s_lshl_b32 s55, s29, 5
  s_add_u32 s54, s54, s55
  s_lshl_b32 s55, s3, 4
  s_add_u32 s54, s54, s55
  s_add_u32 s54, s54, 1048576
  v_min_u32 v140, 47, v0
  v_and_b32 v12, 0x3c, v0
  v_add_u32 v139, v12, v0
  v_lshlrev_b32 v139, 11, v139
  v_and_b32 v12, 0x3c, v140
  v_add_u32 v140, v12, v140
  v_lshlrev_b32 v140, 11, v140
  v_add_u32 v139, s54, v139
  s_add_u32 s54, s54, 262144
  v_add_u32 v140, s54, v140
  s_lshl_b32 s54, s28, 3
  s_lshl_b32 s55, s3, 2
  s_add_u32 s54, s54, s55
  v_add_u32 v14, s54, v4
  v_lshlrev_b32 v141, 2, v14
  s_lshl_b32 s55, s29, 6
  v_lshl_add_u32 v142, v14, 1, s55
  s_waitcnt vmcnt(8)
  v_lshlrev_b32 v184, 16, v176
  v_and_b32 v185, 0xffff0000, v176
  v_lshlrev_b32 v186, 16, v177
  v_and_b32 v187, 0xffff0000, v177
  v_lshlrev_b32 v188, 16, v178
  v_and_b32 v189, 0xffff0000, v178
  v_lshlrev_b32 v190, 16, v179
  v_and_b32 v191, 0xffff0000, v179
  v_add_f32 v12, v184, v185
  v_add_f32 v12, v12, v186
  v_add_f32 v12, v12, v187
  v_add_f32 v12, v12, v188
  v_add_f32 v12, v12, v189
  v_add_f32 v12, v12, v190
  v_add_f32 v12, v12, v191
  s_nop 1
  v_add_f32_dpp v12, v12, v12 row_ror:8 row_mask:0xf bank_mask:0xf
  s_nop 1
  v_add_f32_dpp v12, v12, v12 row_ror:4 row_mask:0xf bank_mask:0xf
  s_nop 1
  v_add_f32_dpp v12, v12, v12 row_ror:2 row_mask:0xf bank_mask:0xf
  s_nop 1
  v_add_f32_dpp v12, v12, v12 row_ror:1 row_mask:0xf bank_mask:0xf
  v_mov_b32 v15, v12
  s_nop 1
  v_permlane16_swap_b32 v12, v15
  v_add_f32 v12, v12, v15
  v_mov_b32 v15, v12
  s_nop 1
  v_permlane32_swap_b32 v12, v15
  v_add_f32 v12, v12, v15
  v_mul_f32 v12, 0x3b000000, v12
  v_sub_f32 v184, v184, v12
  v_sub_f32 v185, v185, v12
  v_sub_f32 v186, v186, v12
  v_sub_f32 v187, v187, v12
  v_sub_f32 v188, v188, v12
  v_sub_f32 v189, v189, v12
  v_sub_f32 v190, v190, v12
  v_sub_f32 v191, v191, v12
  v_mul_f32 v13, v184, v184
  v_fmac_f32 v13, v185, v185
  v_fmac_f32 v13, v186, v186
  v_fmac_f32 v13, v187, v187
  v_fmac_f32 v13, v188, v188
  v_fmac_f32 v13, v189, v189
  v_fmac_f32 v13, v190, v190
  v_fmac_f32 v13, v191, v191
  s_nop 1
  v_add_f32_dpp v13, v13, v13 row_ror:8 row_mask:0xf bank_mask:0xf
  s_nop 1
  v_add_f32_dpp v13, v13, v13 row_ror:4 row_mask:0xf bank_mask:0xf
  s_nop 1
  v_add_f32_dpp v13, v13, v13 row_ror:2 row_mask:0xf bank_mask:0xf
  s_nop 1
  v_add_f32_dpp v13, v13, v13 row_ror:1 row_mask:0xf bank_mask:0xf
  v_mov_b32 v15, v13
  s_nop 1
  v_permlane16_swap_b32 v13, v15
  v_add_f32 v13, v13, v15
  v_mov_b32 v15, v13
  s_nop 1
  v_permlane32_swap_b32 v13, v15
  v_add_f32 v13, v13, v15
  v_mul_f32 v13, 0x3b000000, v13
  v_cvt_pk_bf16_f32 v14, v12, v13
  v_lshlrev_b32 v12, 16, v14
  v_and_b32 v13, 0xffff0000, v14
  v_add_f32 v13, 0x3727c5ac, v13
  v_cvt_pk_bf16_f32 v13, v13, v13
  v_and_b32 v13, 0xffff0000, v13
  v_sqrt_f32 v13, v13
  s_nop 0
  v_cvt_pk_bf16_f32 v13, v13, v13
  v_and_b32 v13, 0xffff0000, v13
  v_rcp_f32 v14, v13
  s_nop 0
  v_fma_f32 v15, -v13, v14, 1.0
  v_fmac_f32 v14, v15, v14
  v_lshlrev_b32 v184, 16, v180
  v_and_b32 v185, 0xffff0000, v180
  v_lshlrev_b32 v186, 16, v181
  v_and_b32 v187, 0xffff0000, v181
  v_lshlrev_b32 v188, 16, v182
  v_and_b32 v189, 0xffff0000, v182
  v_lshlrev_b32 v190, 16, v183
  v_and_b32 v191, 0xffff0000, v183
  v_sub_f32 v184, v184, v12
  v_sub_f32 v185, v185, v12
  v_sub_f32 v186, v186, v12
  v_sub_f32 v187, v187, v12
  v_sub_f32 v188, v188, v12
  v_sub_f32 v189, v189, v12
  v_sub_f32 v190, v190, v12
  v_sub_f32 v191, v191, v12
  v_cvt_pk_bf16_f32 v180, v184, v185
  v_cvt_pk_bf16_f32 v181, v186, v187
  v_cvt_pk_bf16_f32 v182, v188, v189
  v_cvt_pk_bf16_f32 v183, v190, v191
  v_lshlrev_b32 v184, 16, v180
  v_and_b32 v185, 0xffff0000, v180
  v_lshlrev_b32 v186, 16, v181
  v_and_b32 v187, 0xffff0000, v181
  v_lshlrev_b32 v188, 16, v182
  v_and_b32 v189, 0xffff0000, v182
  v_lshlrev_b32 v190, 16, v183
  v_and_b32 v191, 0xffff0000, v183
  v_mul_f32 v32, v184, v14
  v_fma_f32 v184, -v32, v13, v184
  v_fmac_f32 v32, v184, v14
  v_mul_f32 v33, v185, v14
  v_fma_f32 v185, -v33, v13, v185
  v_fmac_f32 v33, v185, v14
  v_mul_f32 v34, v186, v14
  v_fma_f32 v186, -v34, v13, v186
  v_fmac_f32 v34, v186, v14
  v_mul_f32 v35, v187, v14
  v_fma_f32 v187, -v35, v13, v187
  v_fmac_f32 v35, v187, v14
  v_mul_f32 v36, v188, v14
  v_fma_f32 v188, -v36, v13, v188
  v_fmac_f32 v36, v188, v14
  v_mul_f32 v37, v189, v14
  v_fma_f32 v189, -v37, v13, v189
  v_fmac_f32 v37, v189, v14
  v_mul_f32 v38, v190, v14
  v_fma_f32 v190, -v38, v13, v190
  v_fmac_f32 v38, v190, v14
  v_mul_f32 v39, v191, v14
  v_fma_f32 v191, -v39, v13, v191
  v_fmac_f32 v39, v191, v14
  v_cvt_pk_bf16_f32 v192, v32, v33
  v_cvt_pk_bf16_f32 v193, v34, v35
  v_cvt_pk_bf16_f32 v194, v36, v37
  v_cvt_pk_bf16_f32 v195, v38, v39
  v_mov_b32 v32, 0
  v_mov_b32 v33, 0
  v_mov_b32 v34, 0
  v_mov_b32 v35, 0
  v_mov_b32 v36, 0
  v_mov_b32 v37, 0
  v_mov_b32 v38, 0
  v_mov_b32 v39, 0
  v_and_b32 v12, 7, v0
  v_lshlrev_b32 v12, 7, v12
  v_lshl_add_u32 v12, v4, 5, v12
  s_lshl_b32 s54, s3, 2
  s_add_u32 s54, s54, 4096
  v_add_u32 v7, s54, v12
  v_lshlrev_b32 v8, 4, v0
  s_lshl_b32 s54, s28, 13
  s_and_b32 s55, s29, 1
  s_lshl_b32 s55, s55, 12
  s_add_u32 s54, s54, s55
  s_bfe_u32 s55, s29, 0x30001
  s_lshl_b32 s55, s55, 9
  s_add_u32 s54, s54, s55
  s_add_u32 s54, s54, 851968
  v_lshl_add_u32 v9, v0, 3, s54
  s_waitcnt lgkmcnt(0)
  s_add_u32 s30, s30, 1
  s_and_b32 s54, s30, 0xff
  s_mul_i32 s34, s54, 0x01010101
  s_mul_i32 s35, s30, 0x9e3779b1
  s_xor_b32 s36, s34, 0x40404040
  s_xor_b32 s37, s34, 0x80808080
  s_lshl_b32 s32, s30, 4
  s_or_b32 s32, s32, s31
  s_waitcnt vmcnt(6)
  v_perm_b32 v40, v100, v96, s40
  v_perm_b32 v41, v100, v96, s41
  v_perm_b32 v42, v101, v97, s40
  v_perm_b32 v43, v101, v97, s41
  v_perm_b32 v44, v102, v98, s40
  v_perm_b32 v45, v102, v98, s41
  v_perm_b32 v46, v103, v99, s40
  v_perm_b32 v47, v103, v99, s41
  v_dot2c_f32_bf16 v32, v40, v192
  v_dot2c_f32_bf16 v33, v41, v192
  v_dot2c_f32_bf16 v34, v42, v192
  v_dot2c_f32_bf16 v35, v43, v192
  v_dot2c_f32_bf16 v36, v44, v192
  v_dot2c_f32_bf16 v37, v45, v192
  v_dot2c_f32_bf16 v38, v46, v192
  v_dot2c_f32_bf16 v39, v47, v192
  s_waitcnt vmcnt(4)
  v_perm_b32 v40, v108, v104, s40
  v_perm_b32 v41, v108, v104, s41
  v_perm_b32 v42, v109, v105, s40
  v_perm_b32 v43, v109, v105, s41
  v_perm_b32 v44, v110, v106, s40
  v_perm_b32 v45, v110, v106, s41
  v_perm_b32 v46, v111, v107, s40
  v_perm_b32 v47, v111, v107, s41
  v_dot2c_f32_bf16 v32, v40, v193
  v_dot2c_f32_bf16 v33, v41, v193
  v_dot2c_f32_bf16 v34, v42, v193
  v_dot2c_f32_bf16 v35, v43, v193
  v_dot2c_f32_bf16 v36, v44, v193
  v_dot2c_f32_bf16 v37, v45, v193
  v_dot2c_f32_bf16 v38, v46, v193
  v_dot2c_f32_bf16 v39, v47, v193
  s_waitcnt vmcnt(2)
  v_perm_b32 v40, v116, v112, s40
  v_perm_b32 v41, v116, v112, s41
  v_perm_b32 v42, v117, v113, s40
  v_perm_b32 v43, v117, v113, s41
  v_perm_b32 v44, v118, v114, s40
  v_perm_b32 v45, v118, v114, s41
  v_perm_b32 v46, v119, v115, s40
  v_perm_b32 v47, v119, v115, s41
  v_dot2c_f32_bf16 v32, v40, v194
  v_dot2c_f32_bf16 v33, v41, v194
  v_dot2c_f32_bf16 v34, v42, v194
  v_dot2c_f32_bf16 v35, v43, v194
  v_dot2c_f32_bf16 v36, v44, v194
  v_dot2c_f32_bf16 v37, v45, v194
  v_dot2c_f32_bf16 v38, v46, v194
  v_dot2c_f32_bf16 v39, v47, v194
  s_waitcnt vmcnt(0)
  v_perm_b32 v40, v124, v120, s40
  v_perm_b32 v41, v124, v120, s41
  v_perm_b32 v42, v125, v121, s40
  v_perm_b32 v43, v125, v121, s41
  v_perm_b32 v44, v126, v122, s40
  v_perm_b32 v45, v126, v122, s41
  v_perm_b32 v46, v127, v123, s40
  v_perm_b32 v47, v127, v123, s41
  v_dot2c_f32_bf16 v32, v40, v195
  v_dot2c_f32_bf16 v33, v41, v195
  v_dot2c_f32_bf16 v34, v42, v195
  v_dot2c_f32_bf16 v35, v43, v195
  v_dot2c_f32_bf16 v36, v44, v195
  v_dot2c_f32_bf16 v37, v45, v195
  v_dot2c_f32_bf16 v38, v46, v195
  v_dot2c_f32_bf16 v39, v47, v195
  v_permlane32_swap_b32 v32, v36
  v_permlane32_swap_b32 v33, v37
  v_permlane32_swap_b32 v34, v38
  v_permlane32_swap_b32 v35, v39
  v_add_f32 v32, v32, v36
  v_add_f32 v33, v33, v37
  v_add_f32 v34, v34, v38
  v_add_f32 v35, v35, v39
  s_nop 0
  v_permlane16_swap_b32 v32, v34
  v_permlane16_swap_b32 v33, v35
  v_add_f32 v32, v32, v34
  v_add_f32 v33, v33, v35
  s_nop 0
  v_add_f32_dpp v32, v32, v32 row_ror:8 row_mask:0xf bank_mask:0xf
  v_add_f32_dpp v33, v33, v33 row_ror:8 row_mask:0xf bank_mask:0xf
  s_mov_b32 exec_lo, 0x00ff00ff
  s_mov_b32 exec_hi, 0x00ff00ff
  ds_write2_b32 v7, v32, v33 offset0:0 offset1:4
  s_mov_b64 exec, -1
  s_waitcnt lgkmcnt(0)
  s_barrier
  s_cmp_lg_u32 s3, 0
  s_cbranch_scc1 L_q_pubdone
  ds_read_b128 v[32:35], v8 offset:4096
  s_lshl_b32 s54, s28, 7
  s_lshl_b32 s55, s29, 2
  s_add_u32 s54, s54, s55
  s_add_u32 s54, s54, 4096
  v_mov_b32 v12, s54
  v_mov_b32 v13, s32
  global_store_dword v12, v13, s[26:27]
  s_waitcnt lgkmcnt(0)
  v_add_f32 v32, v32, v33
  v_add_f32 v34, v34, v35
  v_mov_b32 v33, s35
  v_add_f32 v32, v32, v34
  global_store_dwordx2 v9, v[32:33], s[26:27]
  v_add_u32 v9, 65536, v9
L_q_pubdone:
  s_barrier
  s_lshl_b32 s57, s3, 12
  s_add_u32 m0, s57, 16384
  s_nop 0
  global_load_lds_dwordx4 v228, s[6:7] nt
  s_add_u32 m0, s57, 17408
  s_nop 0
  global_load_lds_dwordx4 v229, s[6:7] nt
  s_add_u32 m0, s57, 18432
  s_nop 0
  global_load_lds_dwordx4 v230, s[6:7] nt
  s_add_u32 m0, s57, 19456
  s_nop 0
  global_load_lds_dwordx4 v231, s[6:7] nt
  s_barrier
  global_load_dwordx4 v[96:99], v128, s[12:13] offset:-4096 nt
  s_cmp_lg_u32 s3, 0
  s_cbranch_scc1 L_l_k0
  global_store_dwordx2 v9, v[32:33], s[26:27] sc1
  s_waitcnt vmcnt(5)
L_l_k0:
  s_barrier
  global_load_dwordx4 v[216:219], v6, s[26:27] offset:-2048 sc1
  global_load_dwordx4 v[220:223], v6, s[26:27] offset:2048 sc1
  global_load_dword v236, v237, s[26:27] offset:0 sc1
  s_barrier
  global_load_dwordx4 v[80:83], v2, s[8:9] offset:0 nt
  global_load_dwordx4 v[84:87], v2, s[8:9] offset:256 nt
  global_load_dwordx4 v[88:91], v2, s[8:9] offset:512 nt
  global_load_dwordx4 v[92:95], v2, s[8:9] offset:768 nt
  s_barrier
  global_load_dwordx4 v[100:103], v128, s[12:13] offset:-3072 nt
  global_load_dwordx4 v[104:107], v128, s[12:13] offset:-2048 nt
  s_waitcnt vmcnt(10)
  ds_read_b128 v[16:19], v238 offset:16384
  v_xor_b32 v13, 64, v238
  ds_read_b128 v[20:23], v13 offset:16384
  v_xor_b32 v13, 128, v238
  ds_read_b128 v[24:27], v13 offset:16384
  v_xor_b32 v13, 192, v238
  ds_read_b128 v[28:31], v13 offset:16384
  global_load_dwordx4 v[108:111], v128, s[12:13] offset:-1024 nt
  global_load_dwordx4 v[112:115], v128, s[12:13] offset:0 nt
  s_waitcnt vmcnt(8)
  v_xor_b32 v12, s35, v217
  v_xor_b32 v13, s35, v219
  v_xor_b32 v14, s35, v221
  v_xor_b32 v15, s35, v223
  v_or3_b32 v12, v12, v13, v14
  v_xor_b32 v13, s32, v236
  v_or_b32 v12, v12, v15
  v_lshrrev_b32 v13, s24, v13
  v_lshrrev_b32 v13, s24, v13
  v_or_b32 v12, v12, v13
  v_cmp_ne_u32 vcc, 0, v12
  s_cbranch_vccz L_qok_l
L_qpoll_l:
  global_load_dwordx4 v[216:219], v6, s[52:53] offset:-2048 sc1
  global_load_dwordx4 v[220:223], v6, s[52:53] offset:2048 sc1
  global_load_dword v236, v237, s[26:27] offset:0 sc1
  s_sub_u32 s60, s60, 1
  s_cbranch_scc1 L_exit
  s_add_u32 s59, s59, 1
  s_cmp_eq_u32 s59, 24
  s_cselect_b32 s54, 65536, 0
  s_cselect_b32 s24, 16, s24
  s_add_u32 s52, s52, s54
  s_addc_u32 s53, s53, 0
  s_waitcnt vmcnt(0)
  v_xor_b32 v12, s35, v217
  v_xor_b32 v13, s35, v219
  v_xor_b32 v14, s35, v221
  v_xor_b32 v15, s35, v223
  v_or3_b32 v12, v12, v13, v14
  v_xor_b32 v13, s32, v236
  v_or_b32 v12, v12, v15
  v_lshrrev_b32 v13, s24, v13
  v_lshrrev_b32 v13, s24, v13
  v_or_b32 v12, v12, v13
  v_cmp_ne_u32 vcc, 0, v12
  s_cbranch_vccnz L_qpoll_l
L_qok_l:
  v_add_f32 v12, v216, v220
  v_add_f32 v13, v218, v222
  v_cvt_pk_bf16_f32 v12, v12, v13
  ds_write_b32 v239, v12 offset:0
  s_waitcnt lgkmcnt(0)
  s_barrier
  ds_read_b128 v[176:179], v240 offset:0
  ds_read_b128 v[180:183], v240 offset:64
  ds_read_b128 v[184:187], v240 offset:128
  ds_read_b128 v[188:191], v240 offset:192
  global_load_dwordx4 v[116:119], v128, s[12:13] offset:1024 nt
  global_load_dwordx4 v[120:123], v128, s[12:13] offset:2048 nt
  global_load_dwordx4 v[124:127], v128, s[12:13] offset:3072 nt
  v_cmp_ne_u32 vcc, s32, v236
  s_nop 0
  s_cmp_eq_u64 vcc, 0
  s_cselect_b32 s33, 1, 0
L_qk_l:
  s_waitcnt lgkmcnt(3)
  v_mfma_f32_16x16x32_bf16 v[192:195], v[16:19], v[176:179], 0
  s_waitcnt lgkmcnt(2)
  v_mfma_f32_16x16x32_bf16 v[192:195], v[20:23], v[180:183], v[192:195]
  s_waitcnt lgkmcnt(1)
  v_mfma_f32_16x16x32_bf16 v[192:195], v[24:27], v[184:187], v[192:195]
  s_waitcnt lgkmcnt(0)
  v_mfma_f32_16x16x32_bf16 v[192:195], v[28:31], v[188:191], v[192:195]
  s_mov_b32 s56, 0x3db504f3
  s_mov_b32 s57, 0x3db504f3
  s_nop 5
  v_cvt_pk_bf16_f32 v208, v192, v193
  v_cvt_pk_bf16_f32 v209, v194, v195
  v_lshlrev_b32 v192, 16, v208
  v_and_b32 v193, 0xffff0000, v208
  v_lshlrev_b32 v194, 16, v209
  v_and_b32 v195, 0xffff0000, v209
  v_pk_mul_f32 v[192:193], v[192:193], s[56:57]
  v_pk_mul_f32 v[194:195], v[194:195], s[56:57]
  v_cvt_pk_bf16_f32 v208, v192, v193
  v_cvt_pk_bf16_f32 v209, v194, v195
  v_lshlrev_b32 v192, 16, v208
  v_and_b32 v193, 0xffff0000, v208
  v_lshlrev_b32 v194, 16, v209
  v_and_b32 v195, 0xffff0000, v209
  v_max3_f32 v12, v192, v193, v194
  v_max_f32 v12, v12, v195
  s_mov_b32 s56, 0x3fb8aa3b
  s_mov_b32 s57, 0x3fb8aa3b
  v_mov_b32 v15, v12
  s_nop 1
  v_permlane16_swap_b32 v12, v15
  v_max_f32 v12, v12, v15
  v_mov_b32 v15, v12
  s_nop 1
  v_permlane32_swap_b32 v12, v15
  v_max_f32 v12, v12, v15
  v_mul_f32 v14, 0xbfb8aa3b, v12
  v_pk_fma_f32 v[192:193], v[192:193], s[56:57], v[14:15] op_sel_hi:[1,1,0]
  v_pk_fma_f32 v[194:195], v[194:195], s[56:57], v[14:15] op_sel_hi:[1,1,0]
  v_exp_f32 v192, v192
  v_exp_f32 v193, v193
  v_exp_f32 v194, v194
  v_exp_f32 v195, v195
  s_nop 0
  v_pk_add_f32 v[216:217], v[192:193], v[194:195]
  v_add_f32 v13, v216, v217
  v_mov_b32 v15, v13
  v_cvt_pk_bf16_f32 v208, v192, v193
  v_cvt_pk_bf16_f32 v209, v194, v195
  v_permlane16_swap_b32 v13, v15
  v_add_f32 v13, v13, v15
  v_mov_b32 v15, v13
  s_nop 1
  v_permlane32_swap_b32 v13, v15
  v_add_f32 v13, v13, v15
  ds_write_b64 v241, v[12:13] offset:1024
  s_waitcnt vmcnt(9)
  v_perm_b32 v144, v84, v80, s40
  v_perm_b32 v146, v84, v80, s41
  v_perm_b32 v148, v85, v81, s40
  v_perm_b32 v150, v85, v81, s41
  v_perm_b32 v152, v86, v82, s40
  v_perm_b32 v154, v86, v82, s41
  v_perm_b32 v156, v87, v83, s40
  v_perm_b32 v158, v87, v83, s41
  s_waitcnt lgkmcnt(0)
  s_barrier
  ds_read_b128 v[216:219], v254 offset:1024
  ds_read_b128 v[220:223], v254 offset:1040
  s_waitcnt lgkmcnt(0)
  v_max3_f32 v12, v216, v218, v220
  v_max_f32 v12, v12, v222
  v_mul_f32 v15, 0xbfb8aa3b, v12
  v_fma_f32 v232, v216, s56, v15
  v_fma_f32 v233, v218, s56, v15
  v_fma_f32 v234, v220, s56, v15
  v_fma_f32 v235, v222, s56, v15
  v_exp_f32 v232, v232
  v_exp_f32 v233, v233
  v_exp_f32 v234, v234
  v_exp_f32 v235, v235
  v_mov_b32 v13, s35
  v_mul_f32 v14, v232, v217
  v_mov_b32 v15, s35
  v_fmac_f32 v14, v233, v219
  v_fmac_f32 v14, v234, v221
  v_fmac_f32 v14, v235, v223
  s_cmp_eq_u32 s33, 0
  s_cbranch_scc1 L_slow_mll
  global_store_dwordx4 v245, v[12:15], s[26:27]
L_back_mll:
  s_waitcnt vmcnt(8)
  v_perm_b32 v145, v92, v88, s40
  v_perm_b32 v147, v92, v88, s41
  v_perm_b32 v149, v93, v89, s40
  v_mfma_f32_16x16x16_bf16 v[48:51], v[208:209], v[144:145], 0
  v_perm_b32 v151, v93, v89, s41
  v_mfma_f32_16x16x16_bf16 v[52:55], v[208:209], v[146:147], 0
  v_perm_b32 v153, v94, v90, s40
  v_mfma_f32_16x16x16_bf16 v[56:59], v[208:209], v[148:149], 0
  v_perm_b32 v155, v94, v90, s41
  v_mfma_f32_16x16x16_bf16 v[60:63], v[208:209], v[150:151], 0
  v_perm_b32 v157, v95, v91, s40
  v_mfma_f32_16x16x16_bf16 v[64:67], v[208:209], v[152:153], 0
  v_perm_b32 v159, v95, v91, s41
  v_mfma_f32_16x16x16_bf16 v[68:71], v[208:209], v[154:155], 0
  v_mfma_f32_16x16x16_bf16 v[72:75], v[208:209], v[156:157], 0
  v_mfma_f32_16x16x16_bf16 v[76:79], v[208:209], v[158:159], 0
  ds_write2_b32 v242, v48, v52 offset0:0 offset1:68
  s_nop 0
  ds_write2_b32 v242, v56, v60 offset0:136 offset1:204
  s_nop 2
  ds_write2_b32 v253, v64, v68 offset0:0 offset1:68
  s_nop 0
  ds_write2_b32 v253, v72, v76 offset0:136 offset1:204
  s_waitcnt lgkmcnt(0)
  s_barrier
  ds_read2_b32 v[192:193], v243 offset0:0 offset1:68
  ds_read2_b32 v[194:195], v205 offset0:0 offset1:68
  ds_read2_b32 v[196:197], v206 offset0:0 offset1:68
  ds_read2_b32 v[198:199], v207 offset0:0 offset1:68
  s_cmp_eq_u32 s33, 0
  s_waitcnt lgkmcnt(2)
  v_pk_mul_f32 v[192:193], v[192:193], v[232:233] op_sel_hi:[1,0]
  v_pk_fma_f32 v[192:193], v[194:195], v[232:233], v[192:193] op_sel:[0,1,0] op_sel_hi:[1,1,1]
  s_waitcnt lgkmcnt(0)
  v_pk_fma_f32 v[192:193], v[196:197], v[234:235], v[192:193] op_sel_hi:[1,0,1]
  v_pk_fma_f32 v[192:193], v[198:199], v[234:235], v[192:193] op_sel:[0,1,0] op_sel_hi:[1,1,1]
  v_perm_b32 v192, v192, s34, v5
  v_perm_b32 v193, v193, s34, v5
  s_cbranch_scc1 L_slow_a1l
  global_store_dwordx2 v244, v[192:193], s[26:27]
L_back_a1l:
  v_lshlrev_b32 v11, 16, v11
  v_cmp_gt_u32 s[42:43], 48, v0
  s_waitcnt vmcnt(8)
  v_perm_b32 v32, v100, v96, s40
  v_perm_b32 v36, v100, v96, s41
  v_perm_b32 v40, v101, v97, s40
  v_perm_b32 v44, v101, v97, s41
  v_perm_b32 v48, v102, v98, s40
  v_perm_b32 v52, v102, v98, s41
  v_perm_b32 v56, v103, v99, s40
  v_perm_b32 v60, v103, v99, s41
  s_waitcnt vmcnt(6)
  v_perm_b32 v33, v108, v104, s40
  v_perm_b32 v37, v108, v104, s41
  v_perm_b32 v41, v109, v105, s40
  v_perm_b32 v45, v109, v105, s41
  v_perm_b32 v49, v110, v106, s40
  v_perm_b32 v53, v110, v106, s41
  v_perm_b32 v57, v111, v107, s40
  v_perm_b32 v61, v111, v107, s41
  s_waitcnt vmcnt(4)
  v_perm_b32 v34, v116, v112, s40
  v_perm_b32 v38, v116, v112, s41
  v_perm_b32 v42, v117, v113, s40
  v_perm_b32 v46, v117, v113, s41
  v_perm_b32 v50, v118, v114, s40
  v_perm_b32 v54, v118, v114, s41
  v_perm_b32 v58, v119, v115, s40
  v_perm_b32 v62, v119, v115, s41
  s_waitcnt vmcnt(2)
  global_load_dwordx4 v[216:219], v129, s[26:27] sc1
  global_load_dwordx4 v[176:179], v130, s[26:27] sc1
  global_load_dword v236, v237, s[26:27] offset:64 sc1
  v_perm_b32 v35, v124, v120, s40
  v_perm_b32 v39, v124, v120, s41
  v_perm_b32 v43, v125, v121, s40
  v_perm_b32 v47, v125, v121, s41
  v_perm_b32 v51, v126, v122, s40
  v_perm_b32 v55, v126, v122, s41
  v_perm_b32 v59, v127, v123, s40
  v_perm_b32 v63, v127, v123, s41
  s_waitcnt vmcnt(2)
  v_mov_b32 v14, v216
  v_xor_b32 v12, s35, v217
  v_xor_b32 v13, s35, v219
  v_or_b32 v12, v12, v13
  v_cmp_ne_u32 vcc, 0, v12
  s_cbranch_vccz L_mlok
L_mlpoll:
  global_load_dwordx4 v[216:219], v129, s[26:27] sc1
  s_sub_u32 s60, s60, 1
  s_cbranch_scc1 L_exit
  s_waitcnt vmcnt(0)
  v_mov_b32 v14, v216
  v_xor_b32 v12, s35, v217
  v_xor_b32 v13, s35, v219
  v_or_b32 v12, v12, v13
  v_cmp_ne_u32 vcc, 0, v12
  s_cbranch_vccnz L_mlpoll
  global_load_dwordx4 v[176:179], v130, s[26:27] sc1
L_mlok:
  v_max_f32_dpp v14, v14, v14 row_ror:8 row_mask:0xf bank_mask:0xf
  s_nop 1
  v_max_f32_dpp v14, v14, v14 row_ror:4 row_mask:0xf bank_mask:0xf
  s_nop 1
  v_max_f32_dpp v14, v14, v14 row_ror:2 row_mask:0xf bank_mask:0xf
  v_mov_b32 v15, v14
  s_nop 1
  v_permlane16_swap_b32 v14, v15
  v_max_f32 v14, v14, v15
  v_mov_b32 v15, v14
  s_nop 1
  v_permlane32_swap_b32 v14, v15
  v_max_f32 v14, v14, v15
  v_sub_f32 v220, v216, v14
  v_mul_f32 v220, 0x3fb8aa3b, v220
  v_exp_f32 v220, v220
  s_nop 0
  v_mul_f32 v14, v220, v218
  s_nop 1
  v_add_f32_dpp v14, v14, v14 row_ror:8 row_mask:0xf bank_mask:0xf
  s_nop 1
  v_add_f32_dpp v14, v14, v14 row_ror:4 row_mask:0xf bank_mask:0xf
  s_nop 1
  v_add_f32_dpp v14, v14, v14 row_ror:2 row_mask:0xf bank_mask:0xf
  v_mov_b32 v15, v14
  s_nop 1
  v_permlane16_swap_b32 v14, v15
  v_add_f32 v14, v14, v15
  v_mov_b32 v15, v14
  s_nop 1
  v_permlane32_swap_b32 v14, v15
  v_add_f32 v14, v14, v15
  v_rcp_f32 v14, v14
  s_nop 0
  v_mul_f32 v220, v220, v14
  s_branch L_a1poll_w
L_a1poll:
  global_load_dwordx4 v[176:179], v130, s[26:27] sc1
  s_sub_u32 s60, s60, 1
  s_cbranch_scc1 L_exit
L_a1poll_w:
  s_waitcnt vmcnt(0)
  v_perm_b32 v12, v177, v176, s38
  v_perm_b32 v13, v179, v178, s39
  v_or_b32 v12, v12, v13
  v_cmp_ne_u32 vcc, s34, v12
  v_and_b32 v192, 0xffffff00, v176
  v_and_b32 v193, 0xffffff00, v177
  v_and_b32 v194, 0xffffff00, v178
  v_and_b32 v195, 0xffffff00, v179
  s_cbranch_vccnz L_a1poll
  v_pk_mul_f32 v[192:193], v[192:193], v[220:221] op_sel_hi:[1,0]
  v_pk_mul_f32 v[194:195], v[194:195], v[220:221] op_sel_hi:[1,0]
  s_nop 1
  v_permlane32_swap_b32 v192, v194
  v_permlane32_swap_b32 v193, v195
  v_add_f32 v192, v192, v194
  v_add_f32 v193, v193, v195
  s_nop 1
  v_permlane16_swap_b32 v192, v193
  v_add_f32 v192, v192, v193
  s_nop 1
  v_add_f32_dpp v192, v192, v192 row_ror:8 row_mask:0xf bank_mask:0xf
  s_nop 1
  v_add_f32_dpp v192, v192, v192 row_ror:4 row_mask:0xf bank_mask:0xf
  s_nop 1
  v_add_f32_dpp v192, v192, v192 row_ror:2 row_mask:0xf bank_mask:0xf
  v_cvt_pk_bf16_f32 v192, v192, v192
  ds_write_b16 v131, v192 offset:1664
  s_waitcnt lgkmcnt(0)
  s_barrier
  ds_read_b128 v[216:219], v132 offset:1664
  s_cmp_eq_u32 s33, 0
  s_waitcnt lgkmcnt(0)
  v_mfma_f32_16x16x32_bf16 v[144:147], v[216:219], v[32:35], 0
  v_mfma_f32_16x16x32_bf16 v[160:163], v[216:219], v[48:51], 0
  v_mfma_f32_16x16x32_bf16 v[148:151], v[216:219], v[36:39], 0
  v_mfma_f32_16x16x32_bf16 v[164:167], v[216:219], v[52:55], 0
  v_mfma_f32_16x16x32_bf16 v[152:155], v[216:219], v[40:43], 0
  v_mfma_f32_16x16x32_bf16 v[168:171], v[216:219], v[56:59], 0
  v_mfma_f32_16x16x32_bf16 v[156:159], v[216:219], v[44:47], 0
  v_mfma_f32_16x16x32_bf16 v[172:175], v[216:219], v[60:63], 0
  s_nop 1
  v_cndmask_b32 v192, v144, v160, s[50:51]
  s_nop 0
  v_cndmask_b32 v193, v148, v164, s[50:51]
  v_perm_b32 v192, v192, s36, v5
  v_cndmask_b32 v194, v152, v168, s[50:51]
  v_perm_b32 v193, v193, s36, v5
  v_cndmask_b32 v195, v156, v172, s[50:51]
  v_perm_b32 v194, v194, s36, v5
  v_perm_b32 v195, v195, s36, v5
  s_cbranch_scc1 L_slow_b1
  global_store_dwordx4 v133, v[192:195], s[26:27]
L_back_b1:
  s_cmp_ge_u32 s3, 2
  s_cbranch_scc1 L_exit
  s_cmp_eq_u32 s3, 1
  s_cbranch_scc1 L_final
L_b1poll:
  global_load_dwordx4 v[176:179], v134, s[26:27] sc1
  global_load_dwordx4 v[180:183], v134, s[26:27] offset:1024 sc1
  s_sub_u32 s60, s60, 1
  s_cbranch_scc1 L_exit
  s_waitcnt vmcnt(1)
  v_perm_b32 v12, v177, v176, s38
  v_perm_b32 v13, v179, v178, s39
  v_or_b32 v12, v12, v13
  v_cmp_ne_u32 s[56:57], s36, v12
  v_and_b32 v80, 0xffffff00, v176
  v_and_b32 v81, 0xffffff00, v177
  v_and_b32 v82, 0xffffff00, v178
  v_and_b32 v83, 0xffffff00, v179
  s_waitcnt vmcnt(0)
  v_perm_b32 v12, v181, v180, s38
  v_perm_b32 v13, v183, v182, s39
  v_or_b32 v12, v12, v13
  v_cmp_ne_u32 vcc, s36, v12
  v_and_b32 v84, 0xffffff00, v180
  v_and_b32 v85, 0xffffff00, v181
  v_and_b32 v86, 0xffffff00, v182
  v_and_b32 v87, 0xffffff00, v183
  s_or_b64 vcc, vcc, s[56:57]
  s_cbranch_vccnz L_b1poll
  v_pk_add_f32 v[80:81], v[80:81], v[84:85]
  v_pk_add_f32 v[82:83], v[82:83], v[86:87]
  s_nop 1
  v_permlane32_swap_b32 v80, v82
  v_permlane32_swap_b32 v81, v83
  v_add_f32 v80, v80, v82
  v_add_f32 v81, v81, v83
  s_nop 1
  v_permlane16_swap_b32 v80, v81
  v_add_f32 v80, v80, v81
  s_nop 1
  v_add_f32_dpp v80, v80, v80 row_ror:8 row_mask:0xf bank_mask:0xf
  v_perm_b32 v80, v80, s34, v5
  global_store_dword v135, v80, s[26:27] sc1
  v_cmp_ne_u32 vcc, s32, v236
  s_nop 0
  s_cmp_eq_u64 vcc, 0
  s_cselect_b32 s33, s33, 0
  s_sleep 11
L_b2poll:
  global_load_dwordx4 v[176:179], v136, s[26:27] sc1
  s_sub_u32 s60, s60, 1
  s_cbranch_scc1 L_exit
  s_waitcnt vmcnt(0)
  v_perm_b32 v12, v177, v176, s38
  v_perm_b32 v13, v179, v178, s39
  v_or_b32 v12, v12, v13
  v_cmp_ne_u32 vcc, s34, v12
  v_and_b32 v80, 0xffffff00, v176
  v_and_b32 v81, 0xffffff00, v177
  v_and_b32 v82, 0xffffff00, v178
  v_and_b32 v83, 0xffffff00, v179
  s_cbranch_vccnz L_b2poll
  v_permlane32_swap_b32 v80, v82
  v_permlane32_swap_b32 v81, v83
  v_add_f32 v80, v80, v82
  v_add_f32 v81, v81, v83
  s_nop 1
  v_permlane16_swap_b32 v80, v81
  v_add_f32 v80, v80, v81
  s_cmp_eq_u32 s33, 0
  s_nop 0
  v_add_f32_dpp v80, v80, v80 row_ror:8 row_mask:0xf bank_mask:0xf
  v_cvt_pk_bf16_f32 v80, v80, v80
  v_and_b32 v80, 0xffff0000, v80
  v_add_f32 v80, v80, v11
  v_cvt_pk_bf16_f32 v80, 0, v80
  v_perm_b32 v81, v80, s37, v5
  s_cbranch_scc1 L_slow_b2b
  global_store_dword v137, v81, s[26:27]
L_back_b2b:
  ds_write_b32 v138, v80 offset:1792
L_final:
  s_cmp_ge_u32 s28, 4
  s_cbranch_scc1 L_exit
  s_waitcnt lgkmcnt(0)
  s_barrier
  ds_read_b32 v11, v141 offset:1792
  s_lshl_b32 s54, s2, 1
  s_add_u32 s54, s54, s3
  s_cmp_lg_u32 s54, 1
  s_cbranch_scc1 L_epoch_done
  s_mov_b64 exec, 1
  v_mov_b32 v12, 0
  v_mov_b32 v13, s30
  global_store_dword v12, v13, s[26:27] sc1
  s_mov_b64 exec, -1
L_epoch_done:
  s_lshl_b32 s54, s28, 13
  s_lshl_b32 s55, s29, 9
  s_add_u32 s54, s54, s55
  s_add_u32 s54, s54, 983040
  v_and_b32 v134, 31, v0
  v_lshl_add_u32 v134, v134, 4, s54
L_eseen:
  global_load_dwordx4 v[176:179], v134, s[26:27] sc1
  s_sub_u32 s60, s60, 1
  s_cbranch_scc1 L_exit
  s_waitcnt vmcnt(0)
  v_perm_b32 v12, v177, v176, s38
  v_perm_b32 v13, v179, v178, s39
  v_or_b32 v12, v12, v13
  v_cmp_ne_u32 vcc, s34, v12
  v_and_b32 v80, 0xffffff00, v176
  v_and_b32 v81, 0xffffff00, v177
  v_and_b32 v82, 0xffffff00, v178
  v_and_b32 v83, 0xffffff00, v179
  s_cbranch_vccnz L_eseen
  s_waitcnt lgkmcnt(0)
  s_sleep 20
L_cpoll:
  global_load_dwordx4 v[176:179], v139, s[26:27] sc1
  global_load_dwordx4 v[180:183], v140, s[26:27] sc1
  s_sub_u32 s60, s60, 1
  s_cbranch_scc1 L_exit
  s_waitcnt vmcnt(1)
  v_perm_b32 v12, v177, v176, s38
  v_perm_b32 v13, v179, v178, s39
  v_or_b32 v12, v12, v13
  v_cmp_ne_u32 s[56:57], s34, v12
  v_and_b32 v80, 0xffffff00, v176
  v_and_b32 v81, 0xffffff00, v177
  v_and_b32 v82, 0xffffff00, v178
  v_and_b32 v83, 0xffffff00, v179
  s_waitcnt vmcnt(0)
  v_perm_b32 v12, v181, v180, s38
  v_perm_b32 v13, v183, v182, s39
  v_or_b32 v12, v12, v13
  v_cmp_ne_u32 vcc, s34, v12
  v_and_b32 v84, 0xffffff00, v180
  v_and_b32 v85, 0xffffff00, v181
  v_and_b32 v86, 0xffffff00, v182
  v_and_b32 v87, 0xffffff00, v183
  s_or_b64 vcc, vcc, s[56:57]
  s_cbranch_vccnz L_cpoll
  s_mov_b64 exec, s[42:43]
  v_pk_add_f32 v[80:81], v[80:81], v[84:85]
  v_pk_add_f32 v[82:83], v[82:83], v[86:87]
  s_mov_b64 exec, -1
  s_nop 0
  v_permlane32_swap_b32 v80, v82
  v_permlane32_swap_b32 v81, v83
  v_add_f32 v80, v80, v82
  v_add_f32 v81, v81, v83
  s_nop 1
  v_permlane16_swap_b32 v80, v81
  v_add_f32 v80, v80, v81
  s_nop 1
  v_add_f32_dpp v80, v80, v80 row_ror:8 row_mask:0xf bank_mask:0xf
  s_nop 1
  v_add_f32_dpp v80, v80, v80 row_ror:4 row_mask:0xf bank_mask:0xf
  s_nop 1
  v_add_f32_dpp v80, v80, v80 row_ror:2 row_mask:0xf bank_mask:0xf
  s_nop 1
  v_add_f32_dpp v80, v80, v80 row_ror:1 row_mask:0xf bank_mask:0xf
  v_cvt_pk_bf16_f32 v80, v80, v80
  v_and_b32 v80, 0xffff0000, v80
  v_add_f32 v80, v80, v11
  v_cvt_pk_bf16_f32 v80, v80, v80
  global_store_short v142, v80, s[22:23]
  s_branch L_exit
L_h_rest:
  s_barrier
  s_add_u32 s62, s8, 262144
  s_addc_u32 s63, s9, 0
  s_add_u32 s100, s8, 524288
  s_addc_u32 s101, s9, 0
  s_mov_b32 s38, 0x0c0c0400
  s_mov_b32 s39, 0x04000c0c
  s_mov_b32 s40, 0x05040100
  s_mov_b32 s41, 0x07060302
  s_mov_b32 s50, 0xffff0000
  s_mov_b32 s51, 0xffff0000
  s_mov_b32 s60, 0x20000
  s_mov_b32 s59, 0
  s_mov_b32 s24, 2
  v_mov_b32 v5, 0x07060500
  s_getreg_b32 s31, hwreg(HW_REG_XCC_ID, 0, 4)
  s_lshl_b32 s54, s28, 7
  s_add_u32 s54, s54, 4096
  v_lshl_add_u32 v237, v3, 2, s54
  s_lshl_b32 s54, s28, 13
  s_lshl_b32 s55, s3, 10
  s_add_u32 s54, s54, s55
  s_add_u32 s54, s54, 854016
  v_lshl_add_u32 v6, v0, 4, s54
  s_mov_b64 s[52:53], s[26:27]
  v_xor_b32 v12, v3, v4
  v_lshlrev_b32 v12, 4, v12
  v_lshl_add_u32 v12, v3, 8, v12
  s_mul_i32 s54, s3, 12288
  v_add_u32 v238, s54, v12
  s_lshl_b32 s54, s3, 8
  v_lshl_add_u32 v239, v0, 2, s54
  v_lshrrev_b32 v12, 2, v3
  v_lshlrev_b32 v13, 8, v12
  v_lshl_add_u32 v240, v4, 4, v13
  s_lshl_b32 s55, s3, 3
  v_lshl_add_u32 v241, v12, 5, s55
  s_mul_i32 s55, s3, 2176
  s_add_u32 s55, s55, 4096
  v_lshl_add_u32 v242, v0, 2, s55
  v_add_u32 v253, 1088, v242
  s_lshl_b32 s55, s3, 5
  v_mov_b32 v254, s55
  s_lshl_b32 s55, s3, 6
  s_add_u32 s55, s55, 4096
  v_and_b32 v12, 0x3c, v0
  v_add_u32 v243, s55, v12
  v_and_b32 v12, 3, v0
  v_mul_u32_u24 v12, 544, v12
  v_add_u32 v243, v12, v243
  v_add_u32 v205, 2176, v243
  v_add_u32 v206, 4352, v243
  v_add_u32 v207, 6528, v243
  s_lshl_b32 s54, s28, 16
  s_lshl_b32 s55, s29, 11
  s_add_u32 s54, s54, s55
  s_lshl_b32 s55, s3, 9
  s_add_u32 s54, s54, s55
  s_add_u32 s54, s54, 65536
  v_lshl_add_u32 v244, v0, 3, s54
  s_lshl_b32 s54, s28, 11
  s_lshl_b32 s55, s29, 6
  s_add_u32 s54, s54, s55
  s_lshl_b32 s55, s3, 4
  s_add_u32 s54, s54, s55
  s_add_u32 s54, s54, 8192
  v_mov_b32 v245, s54
  s_lshl_b32 s58, s28, 4
  s_add_u32 s58, s58, s29
  s_sub_u32 s58, s58, 16
  s_and_b32 s61, s58, 3
  s_lshl_b32 s54, s61, 2
  s_add_u32 s54, s54, s3
  s_mul_i32 s54, s54, 114688
  s_lshr_b32 s55, s58, 2
  s_lshl_b32 s55, s55, 7
  s_add_u32 s54, s54, s55
  v_lshrrev_b32 v12, 3, v0
  v_mul_u32_u24 v12, 3584, v12
  v_and_b32 v13, 7, v0
  v_lshl_add_u32 v12, v13, 4, v12
  v_add_u32 v246, s54, v12
  s_lshl_b32 s54, s58, 14
  s_lshl_b32 s55, s3, 8
  s_add_u32 s54, s54, s55
  v_lshlrev_b32 v12, 12, v4
  v_lshl_add_u32 v12, v3, 4, v12
  v_add_u32 v247, s54, v12
  v_lshrrev_b32 v12, 2, v3
  v_and_b32 v13, 3, v0
  v_lshlrev_b32 v248, 11, v4
  v_lshl_add_u32 v248, v12, 7, v248
  v_lshl_add_u32 v248, v13, 3, v248
  s_lshl_b32 s54, s3, 5
  v_add_u32 v248, s54, v248
  v_lshlrev_b32 v249, 9, v12
  v_lshl_add_u32 v249, v4, 6, v249
  v_lshl_add_u32 v249, v13, 4, v249
  s_lshl_b32 s54, s28, 16
  s_add_u32 s54, s54, 98304
  v_add_u32 v249, s54, v249
  s_and_b32 s54, s58, 0xfc
  s_add_u32 s54, s54, s3
  s_lshl_b32 s54, s54, 9
  s_lshl_b32 s55, s61, 3
  s_add_u32 s54, s54, s55
  s_add_u32 s54, s54, 983040
  v_lshl_add_u32 v250, v3, 5, s54
  s_lshl_b32 s54, s58, 9
  s_add_u32 s54, s54, 983040
  v_lshrrev_b32 v14, 2, v0
  v_lshl_add_u32 v251, v14, 5, s54
  v_and_b32 v14, 1, v0
  v_lshl_add_u32 v251, v14, 4, v251
  v_lshlrev_b32 v252, 9, v13
  v_lshl_add_u32 v252, v12, 5, v252
  v_and_b32 v13, 1, v4
  v_lshl_add_u32 v252, v13, 4, v252
  s_and_b32 s54, s58, 252
  s_add_u32 s54, s54, s58
  s_lshl_b32 s54, s54, 11
  s_lshl_b32 s55, s3, 7
  s_add_u32 s54, s54, s55
  s_add_u32 s54, s54, 1048576
  v_add_u32 v252, s54, v252
  s_lshl_b32 s54, s61, 4
  s_mov_b64 s[98:99], 0xffff
  s_lshl_b64 s[98:99], s[98:99], s54
  s_waitcnt vmcnt(7)
  s_add_u32 m0, s57, 24576
  s_nop 0
  global_load_lds_dwordx4 v228, s[14:15] nt
  s_waitcnt vmcnt(8)
  s_add_u32 m0, s57, 25600
  s_nop 0
  global_load_lds_dwordx4 v229, s[14:15] nt
  s_waitcnt vmcnt(9)
  s_add_u32 m0, s57, 26624
  s_nop 0
  global_load_lds_dwordx4 v230, s[14:15] nt
  s_waitcnt vmcnt(9)
  s_add_u32 m0, s57, 27648
  s_nop 0
  global_load_lds_dwordx4 v231, s[14:15] nt
  s_waitcnt lgkmcnt(0)
  s_add_u32 s30, s30, 1
  s_and_b32 s54, s30, 0xff
  s_mul_i32 s34, s54, 0x01010101
  s_mul_i32 s35, s30, 0x9e3779b1
  s_xor_b32 s36, s34, 0x40404040
  s_xor_b32 s37, s34, 0x80808080
  s_lshl_b32 s32, s30, 4
  s_or_b32 s32, s32, s31
  s_cmp_lg_u32 s3, 3
  s_cbranch_scc1 L_h_census
  s_lshl_b32 s54, s28, 7
  s_lshl_b32 s55, s29, 2
  s_add_u32 s54, s54, s55
  s_add_u32 s54, s54, 4096
  v_mov_b32 v12, s54
  v_mov_b32 v13, s32
  global_store_dword v12, v13, s[26:27]
L_h_census:
  s_waitcnt vmcnt(9)
  global_load_dwordx4 v[80:83], v2, s[8:9] offset:0 nt
  s_waitcnt vmcnt(9)
  global_load_dwordx4 v[84:87], v2, s[8:9] offset:256 nt
  s_waitcnt vmcnt(9)
  global_load_dwordx4 v[88:91], v2, s[8:9] offset:512 nt
  s_waitcnt vmcnt(9)
  global_load_dwordx4 v[92:95], v2, s[8:9] offset:768 nt
  s_waitcnt vmcnt(9)
  global_load_dwordx4 v[96:99], v2, s[62:63] offset:0 nt
  s_waitcnt vmcnt(9)
  global_load_dwordx4 v[100:103], v2, s[62:63] offset:256 nt
  s_waitcnt vmcnt(9)
  global_load_dwordx4 v[104:107], v2, s[62:63] offset:512 nt
  s_waitcnt vmcnt(9)
  global_load_dwordx4 v[108:111], v2, s[62:63] offset:768 nt
  s_waitcnt vmcnt(3)
  s_barrier
  global_load_dwordx4 v[216:219], v6, s[26:27] offset:-2048 sc1
  global_load_dwordx4 v[220:223], v6, s[26:27] offset:2048 sc1
  global_load_dword v236, v237, s[26:27] offset:0 sc1
  s_barrier
  global_load_dwordx4 v[112:115], v2, s[100:101] offset:0 nt
  global_load_dwordx4 v[116:119], v2, s[100:101] offset:256 nt
  global_load_dwordx4 v[120:123], v2, s[100:101] offset:512 nt
  global_load_dwordx4 v[124:127], v2, s[100:101] offset:768 nt
  s_waitcnt vmcnt(15)
  ds_read_b128 v[16:19], v238 offset:16384
  ds_read_b128 v[32:35], v238 offset:20480
  ds_read_b128 v[48:51], v238 offset:24576
  v_xor_b32 v13, 64, v238
  ds_read_b128 v[20:23], v13 offset:16384
  ds_read_b128 v[36:39], v13 offset:20480
  ds_read_b128 v[52:55], v13 offset:24576
  v_xor_b32 v13, 128, v238
  ds_read_b128 v[24:27], v13 offset:16384
  ds_read_b128 v[40:43], v13 offset:20480
  ds_read_b128 v[56:59], v13 offset:24576
  v_xor_b32 v13, 192, v238
  ds_read_b128 v[28:31], v13 offset:16384
  ds_read_b128 v[44:47], v13 offset:20480
  ds_read_b128 v[60:63], v13 offset:24576
  s_waitcnt vmcnt(13)
  v_perm_b32 v144, v84, v80, s40
  v_perm_b32 v148, v84, v80, s41
  v_perm_b32 v152, v85, v81, s40
  v_perm_b32 v156, v85, v81, s41
  v_perm_b32 v160, v86, v82, s40
  v_perm_b32 v164, v86, v82, s41
  v_perm_b32 v168, v87, v83, s40
  v_perm_b32 v172, v87, v83, s41
  s_waitcnt vmcnt(4)
  v_xor_b32 v12, s35, v217
  v_xor_b32 v13, s35, v219
  v_xor_b32 v14, s35, v221
  v_xor_b32 v15, s35, v223
  v_or3_b32 v12, v12, v13, v14
  v_xor_b32 v13, s32, v236
  v_or_b32 v12, v12, v15
  v_lshrrev_b32 v13, s24, v13
  v_lshrrev_b32 v13, s24, v13
  v_or_b32 v12, v12, v13
  v_cmp_ne_u32 vcc, 0, v12
  s_cbranch_vccz L_qok_h
L_qpoll_h:
  global_load_dwordx4 v[216:219], v6, s[52:53] offset:-2048 sc1
  global_load_dwordx4 v[220:223], v6, s[52:53] offset:2048 sc1
  global_load_dword v236, v237, s[26:27] offset:0 sc1
  s_sub_u32 s60, s60, 1
  s_cbranch_scc1 L_exit
  s_add_u32 s59, s59, 1
  s_cmp_eq_u32 s59, 24
  s_cselect_b32 s54, 65536, 0
  s_cselect_b32 s24, 16, s24
  s_add_u32 s52, s52, s54
  s_addc_u32 s53, s53, 0
  s_waitcnt vmcnt(0)
  v_xor_b32 v12, s35, v217
  v_xor_b32 v13, s35, v219
  v_xor_b32 v14, s35, v221
  v_xor_b32 v15, s35, v223
  v_or3_b32 v12, v12, v13, v14
  v_xor_b32 v13, s32, v236
  v_or_b32 v12, v12, v15
  v_lshrrev_b32 v13, s24, v13
  v_lshrrev_b32 v13, s24, v13
  v_or_b32 v12, v12, v13
  v_cmp_ne_u32 vcc, 0, v12
  s_cbranch_vccnz L_qpoll_h
L_qok_h:
  v_add_f32 v12, v216, v220
  v_add_f32 v13, v218, v222
  v_cvt_pk_bf16_f32 v12, v12, v13
  ds_write_b32 v239, v12 offset:0
  s_waitcnt lgkmcnt(0)
  s_barrier
  ds_read_b128 v[176:179], v240 offset:0
  ds_read_b128 v[180:183], v240 offset:64
  ds_read_b128 v[184:187], v240 offset:128
  ds_read_b128 v[188:191], v240 offset:192
  v_cmp_ne_u32 vcc, s32, v236
  s_nop 0
  s_cmp_eq_u64 vcc, 0
  s_cselect_b32 s33, 1, 0
L_qk_h:
  s_waitcnt lgkmcnt(3)
  v_mfma_f32_16x16x32_bf16 v[192:195], v[16:19], v[176:179], 0
  v_perm_b32 v145, v92, v88, s40
  v_perm_b32 v149, v92, v88, s41
  v_mfma_f32_16x16x32_bf16 v[196:199], v[32:35], v[176:179], 0
  v_perm_b32 v153, v93, v89, s40
  v_perm_b32 v157, v93, v89, s41
  v_mfma_f32_16x16x32_bf16 v[200:203], v[48:51], v[176:179], 0
  v_perm_b32 v161, v94, v90, s40
  v_perm_b32 v165, v94, v90, s41
  s_waitcnt lgkmcnt(2)
  v_mfma_f32_16x16x32_bf16 v[192:195], v[20:23], v[180:183], v[192:195]
  v_perm_b32 v169, v95, v91, s40
  v_perm_b32 v173, v95, v91, s41
  v_mfma_f32_16x16x32_bf16 v[196:199], v[36:39], v[180:183], v[196:199]
  v_perm_b32 v146, v100, v96, s40
  v_perm_b32 v150, v100, v96, s41
  v_mfma_f32_16x16x32_bf16 v[200:203], v[52:55], v[180:183], v[200:203]
  v_perm_b32 v154, v101, v97, s40
  v_perm_b32 v158, v101, v97, s41
  s_waitcnt lgkmcnt(1)
  v_mfma_f32_16x16x32_bf16 v[192:195], v[24:27], v[184:187], v[192:195]
  v_perm_b32 v162, v102, v98, s40
  v_perm_b32 v166, v102, v98, s41
  v_mfma_f32_16x16x32_bf16 v[196:199], v[40:43], v[184:187], v[196:199]
  v_perm_b32 v170, v103, v99, s40
  v_perm_b32 v174, v103, v99, s41
  v_mfma_f32_16x16x32_bf16 v[200:203], v[56:59], v[184:187], v[200:203]
  v_perm_b32 v147, v108, v104, s40
  v_perm_b32 v151, v108, v104, s41
  s_waitcnt lgkmcnt(0)
  v_mfma_f32_16x16x32_bf16 v[192:195], v[28:31], v[188:191], v[192:195]
  v_perm_b32 v155, v109, v105, s40
  v_perm_b32 v159, v109, v105, s41
  v_mfma_f32_16x16x32_bf16 v[196:199], v[44:47], v[188:191], v[196:199]
  v_perm_b32 v163, v110, v106, s40
  v_perm_b32 v167, v110, v106, s41
  v_mfma_f32_16x16x32_bf16 v[200:203], v[60:63], v[188:191], v[200:203]
  v_perm_b32 v171, v111, v107, s40
  v_perm_b32 v175, v111, v107, s41
  s_mov_b32 s56, 0x3db504f3
  s_mov_b32 s57, 0x3db504f3
  v_cvt_pk_bf16_f32 v208, v192, v193
  v_cvt_pk_bf16_f32 v209, v194, v195
  v_cvt_pk_bf16_f32 v210, v196, v197
  v_cvt_pk_bf16_f32 v211, v198, v199
  v_cvt_pk_bf16_f32 v212, v200, v201
  v_cvt_pk_bf16_f32 v213, v202, v203
  v_lshlrev_b32 v192, 16, v208
  v_and_b32 v193, 0xffff0000, v208
  v_lshlrev_b32 v194, 16, v209
  v_and_b32 v195, 0xffff0000, v209
  v_lshlrev_b32 v196, 16, v210
  v_and_b32 v197, 0xffff0000, v210
  v_lshlrev_b32 v198, 16, v211
  v_and_b32 v199, 0xffff0000, v211
  v_lshlrev_b32 v200, 16, v212
  v_and_b32 v201, 0xffff0000, v212
  v_lshlrev_b32 v202, 16, v213
  v_and_b32 v203, 0xffff0000, v213
  v_pk_mul_f32 v[192:193], v[192:193], s[56:57]
  v_pk_mul_f32 v[194:195], v[194:195], s[56:57]
  v_pk_mul_f32 v[196:197], v[196:197], s[56:57]
  v_pk_mul_f32 v[198:199], v[198:199], s[56:57]
  v_pk_mul_f32 v[200:201], v[200:201], s[56:57]
  v_pk_mul_f32 v[202:203], v[202:203], s[56:57]
  v_cvt_pk_bf16_f32 v208, v192, v193
  v_cvt_pk_bf16_f32 v209, v194, v195
  v_cvt_pk_bf16_f32 v210, v196, v197
  v_cvt_pk_bf16_f32 v211, v198, v199
  v_cvt_pk_bf16_f32 v212, v200, v201
  v_cvt_pk_bf16_f32 v213, v202, v203
  v_lshlrev_b32 v192, 16, v208
  v_and_b32 v193, 0xffff0000, v208
  v_lshlrev_b32 v194, 16, v209
  v_and_b32 v195, 0xffff0000, v209
  v_lshlrev_b32 v196, 16, v210
  v_and_b32 v197, 0xffff0000, v210
  v_lshlrev_b32 v198, 16, v211
  v_and_b32 v199, 0xffff0000, v211
  v_lshlrev_b32 v200, 16, v212
  v_and_b32 v201, 0xffff0000, v212
  v_lshlrev_b32 v202, 16, v213
  v_and_b32 v203, 0xffff0000, v213
  v_max3_f32 v12, v192, v193, v194
  v_max3_f32 v12, v12, v195, v196
  v_max3_f32 v12, v12, v197, v198
  v_max3_f32 v12, v12, v199, v200
  v_max3_f32 v12, v12, v201, v202
  v_max_f32 v12, v12, v203
  s_mov_b32 s56, 0x3fb8aa3b
  s_mov_b32 s57, 0x3fb8aa3b
  v_mov_b32 v15, v12
  s_nop 1
  v_permlane16_swap_b32 v12, v15
  v_max_f32 v12, v12, v15
  v_mov_b32 v15, v12
  s_nop 1
  v_permlane32_swap_b32 v12, v15
  v_max_f32 v12, v12, v15
  v_mul_f32 v14, 0xbfb8aa3b, v12
  v_pk_fma_f32 v[192:193], v[192:193], s[56:57], v[14:15] op_sel_hi:[1,1,0]
  v_pk_fma_f32 v[194:195], v[194:195], s[56:57], v[14:15] op_sel_hi:[1,1,0]
  v_pk_fma_f32 v[196:197], v[196:197], s[56:57], v[14:15] op_sel_hi:[1,1,0]
  v_pk_fma_f32 v[198:199], v[198:199], s[56:57], v[14:15] op_sel_hi:[1,1,0]
  v_pk_fma_f32 v[200:201], v[200:201], s[56:57], v[14:15] op_sel_hi:[1,1,0]
  v_pk_fma_f32 v[202:203], v[202:203], s[56:57], v[14:15] op_sel_hi:[1,1,0]
  v_exp_f32 v192, v192
  v_exp_f32 v193, v193
  v_exp_f32 v194, v194
  v_exp_f32 v195, v195
  v_exp_f32 v196, v196
  v_exp_f32 v197, v197
  v_exp_f32 v198, v198
  v_exp_f32 v199, v199
  v_exp_f32 v200, v200
  v_exp_f32 v201, v201
  v_exp_f32 v202, v202
  v_exp_f32 v203, v203
  v_pk_add_f32 v[216:217], v[192:193], v[194:195]
  v_pk_add_f32 v[216:217], v[216:217], v[196:197]
  v_pk_add_f32 v[216:217], v[216:217], v[198:199]
  v_pk_add_f32 v[216:217], v[216:217], v[200:201]
  v_pk_add_f32 v[216:217], v[216:217], v[202:203]
  v_add_f32 v13, v216, v217
  v_mov_b32 v15, v13
  v_cvt_pk_bf16_f32 v208, v192, v193
  v_cvt_pk_bf16_f32 v209, v194, v195
  v_permlane16_swap_b32 v13, v15
  v_add_f32 v13, v13, v15
  v_mov_b32 v15, v13
  v_cvt_pk_bf16_f32 v210, v196, v197
  v_cvt_pk_bf16_f32 v211, v198, v199
  v_permlane32_swap_b32 v13, v15
  v_add_f32 v13, v13, v15
  ds_write_b64 v241, v[12:13] offset:1024
  v_cvt_pk_bf16_f32 v212, v200, v201
  v_cvt_pk_bf16_f32 v213, v202, v203
  v_mfma_f32_16x16x32_bf16 v[16:19], v[208:211], v[144:147], 0
  v_mfma_f32_16x16x32_bf16 v[20:23], v[208:211], v[148:151], 0
  s_waitcnt lgkmcnt(0)
  s_barrier
  ds_read_b128 v[216:219], v254 offset:1024
  ds_read_b128 v[220:223], v254 offset:1040
  v_mfma_f32_16x16x32_bf16 v[24:27], v[208:211], v[152:155], 0
  v_mfma_f32_16x16x32_bf16 v[28:31], v[208:211], v[156:159], 0
  v_mfma_f32_16x16x32_bf16 v[32:35], v[208:211], v[160:163], 0
  s_waitcnt lgkmcnt(0)
  v_max3_f32 v12, v216, v218, v220
  v_max_f32 v12, v12, v222
  v_mfma_f32_16x16x32_bf16 v[36:39], v[208:211], v[164:167], 0
  v_mul_f32 v15, 0xbfb8aa3b, v12
  v_fma_f32 v232, v216, s56, v15
  v_mfma_f32_16x16x32_bf16 v[40:43], v[208:211], v[168:171], 0
  v_fma_f32 v233, v218, s56, v15
  v_fma_f32 v234, v220, s56, v15
  v_mfma_f32_16x16x32_bf16 v[44:47], v[208:211], v[172:175], 0
  v_fma_f32 v235, v222, s56, v15
  v_exp_f32 v232, v232
  v_exp_f32 v233, v233
  v_exp_f32 v234, v234
  v_exp_f32 v235, v235
  v_mov_b32 v13, s35
  v_mul_f32 v14, v232, v217
  v_mov_b32 v15, s35
  v_fmac_f32 v14, v233, v219
  v_fmac_f32 v14, v234, v221
  v_fmac_f32 v14, v235, v223
  s_cmp_eq_u32 s33, 0
  s_cbranch_scc1 L_slow_mlh
  global_store_dwordx4 v245, v[12:15], s[26:27]
L_back_mlh:
  s_waitcnt vmcnt(3)
  v_perm_b32 v80, v116, v112, s40
  v_perm_b32 v82, v116, v112, s41
  v_perm_b32 v84, v117, v113, s40
  v_perm_b32 v86, v117, v113, s41
  v_perm_b32 v88, v118, v114, s40
  v_perm_b32 v90, v118, v114, s41
  v_perm_b32 v92, v119, v115, s40
  v_perm_b32 v94, v119, v115, s41
  s_waitcnt vmcnt(1)
  v_perm_b32 v81, v124, v120, s40
  v_perm_b32 v83, v124, v120, s41
  v_perm_b32 v85, v125, v121, s40
  v_mfma_f32_16x16x16_bf16 v[16:19], v[212:213], v[80:81], v[16:19]
  v_perm_b32 v87, v125, v121, s41
  v_mfma_f32_16x16x16_bf16 v[20:23], v[212:213], v[82:83], v[20:23]
  v_perm_b32 v89, v126, v122, s40
  v_mfma_f32_16x16x16_bf16 v[24:27], v[212:213], v[84:85], v[24:27]
  v_perm_b32 v91, v126, v122, s41
  v_mfma_f32_16x16x16_bf16 v[28:31], v[212:213], v[86:87], v[28:31]
  v_perm_b32 v93, v127, v123, s40
  v_mfma_f32_16x16x16_bf16 v[32:35], v[212:213], v[88:89], v[32:35]
  v_perm_b32 v95, v127, v123, s41
  v_mfma_f32_16x16x16_bf16 v[36:39], v[212:213], v[90:91], v[36:39]
  v_mfma_f32_16x16x16_bf16 v[40:43], v[212:213], v[92:93], v[40:43]
  v_mfma_f32_16x16x16_bf16 v[44:47], v[212:213], v[94:95], v[44:47]
  ds_write2_b32 v242, v16, v20 offset0:0 offset1:68
  s_nop 0
  ds_write2_b32 v242, v24, v28 offset0:136 offset1:204
  s_nop 2
  ds_write2_b32 v253, v32, v36 offset0:0 offset1:68
  s_nop 0
  ds_write2_b32 v253, v40, v44 offset0:136 offset1:204
  s_waitcnt lgkmcnt(0)
  s_barrier
  ds_read2_b32 v[192:193], v243 offset0:0 offset1:68
  ds_read2_b32 v[194:195], v205 offset0:0 offset1:68
  ds_read2_b32 v[196:197], v206 offset0:0 offset1:68
  ds_read2_b32 v[198:199], v207 offset0:0 offset1:68
  s_cmp_eq_u32 s33, 0
  s_waitcnt lgkmcnt(2)
  v_pk_mul_f32 v[192:193], v[192:193], v[232:233] op_sel_hi:[1,0]
  v_pk_fma_f32 v[192:193], v[194:195], v[232:233], v[192:193] op_sel:[0,1,0] op_sel_hi:[1,1,1]
  s_waitcnt lgkmcnt(0)
  v_pk_fma_f32 v[192:193], v[196:197], v[234:235], v[192:193] op_sel_hi:[1,0,1]
  v_pk_fma_f32 v[192:193], v[198:199], v[234:235], v[192:193] op_sel:[0,1,0] op_sel_hi:[1,1,1]
  v_perm_b32 v192, v192, s34, v5
  v_perm_b32 v193, v193, s34, v5
  s_cbranch_scc1 L_slow_a1h
  global_store_dwordx2 v244, v[192:193], s[26:27]
L_back_a1h:
  s_barrier
  s_cmp_eq_u32 s28, 7
  s_cbranch_scc1 L_exit
  s_lshl_b32 s56, s3, 12
  s_add_u32 m0, s56, 16384
  s_nop 0
  global_load_lds_dwordx4 v246, s[16:17] nt
  s_add_u32 m0, s56, 32768
  s_nop 0
  global_load_lds_dwordx4 v246, s[18:19] nt
  v_add_u32 v246, 28672, v246
  s_add_u32 m0, s56, 17408
  s_nop 0
  global_load_lds_dwordx4 v246, s[16:17] nt
  s_add_u32 m0, s56, 33792
  s_nop 0
  global_load_lds_dwordx4 v246, s[18:19] nt
  v_add_u32 v246, 28672, v246
  s_add_u32 m0, s56, 18432
  s_nop 0
  global_load_lds_dwordx4 v246, s[16:17] nt
  s_add_u32 m0, s56, 34816
  s_nop 0
  global_load_lds_dwordx4 v246, s[18:19] nt
  v_add_u32 v246, 28672, v246
  s_add_u32 m0, s56, 19456
  s_nop 0
  global_load_lds_dwordx4 v246, s[16:17] nt
  s_add_u32 m0, s56, 35840
  s_nop 0
  global_load_lds_dwordx4 v246, s[18:19] nt
  global_load_dwordx4 v[80:83], v247, s[20:21] offset:0 nt
  global_load_dwordx4 v[84:87], v247, s[20:21] offset:1024 nt
  global_load_dwordx4 v[88:91], v247, s[20:21] offset:2048 nt
  global_load_dwordx4 v[92:95], v247, s[20:21] offset:3072 nt
  global_load_dwordx4 v[152:155], v251, s[26:27] sc1
  global_load_dword v236, v237, s[26:27] offset:64 sc1
  v_mov_b32 v224, 0x3f803f80
  v_mov_b32 v216, 0x3f803f80
  v_mov_b32 v217, 0x3f803f80
  v_mov_b32 v218, 0x3f803f80
  v_mov_b32 v219, 0x3f803f80
  s_waitcnt vmcnt(6)
  s_barrier
  ds_read_b64_tr_b16 v[16:17], v248 offset:16384
  ds_read_b64_tr_b16 v[18:19], v248 offset:24576
  ds_read_b64_tr_b16 v[20:21], v248 offset:16896
  ds_read_b64_tr_b16 v[22:23], v248 offset:25088
  ds_read_b64_tr_b16 v[24:25], v248 offset:17408
  ds_read_b64_tr_b16 v[26:27], v248 offset:25600
  ds_read_b64_tr_b16 v[28:29], v248 offset:17920
  ds_read_b64_tr_b16 v[30:31], v248 offset:26112
  ds_read_b64_tr_b16 v[32:33], v248 offset:32768
  ds_read_b64_tr_b16 v[34:35], v248 offset:40960
  ds_read_b64_tr_b16 v[36:37], v248 offset:33280
  ds_read_b64_tr_b16 v[38:39], v248 offset:41472
  ds_read_b64_tr_b16 v[40:41], v248 offset:33792
  ds_read_b64_tr_b16 v[42:43], v248 offset:41984
  ds_read_b64_tr_b16 v[44:45], v248 offset:34304
  ds_read_b64_tr_b16 v[46:47], v248 offset:42496
  s_waitcnt lgkmcnt(0)
  v_mfma_f32_16x16x32_bf16 v[144:147], v[216:219], v[16:19], 0
  v_mfma_f32_16x16x32_bf16 v[148:151], v[216:219], v[32:35], 0
  v_mfma_f32_16x16x32_bf16 v[144:147], v[216:219], v[20:23], v[144:147]
  v_mfma_f32_16x16x32_bf16 v[148:151], v[216:219], v[36:39], v[148:151]
  v_mfma_f32_16x16x32_bf16 v[144:147], v[216:219], v[24:27], v[144:147]
  v_mfma_f32_16x16x32_bf16 v[148:151], v[216:219], v[40:43], v[148:151]
  v_mfma_f32_16x16x32_bf16 v[144:147], v[216:219], v[28:31], v[144:147]
  v_mfma_f32_16x16x32_bf16 v[148:151], v[216:219], v[44:47], v[148:151]
  s_waitcnt vmcnt(0)
  v_perm_b32 v96, v84, v80, s40
  v_perm_b32 v98, v84, v80, s41
  v_perm_b32 v97, v92, v88, s40
  v_perm_b32 v99, v92, v88, s41
  v_perm_b32 v100, v85, v81, s40
  v_perm_b32 v102, v85, v81, s41
  v_perm_b32 v101, v93, v89, s40
  v_perm_b32 v103, v93, v89, s41
  v_perm_b32 v104, v90, v86, s40
  v_perm_b32 v106, v90, v86, s41
  v_perm_b32 v105, v82, v94, s40
  v_perm_b32 v107, v82, v94, s41
  v_perm_b32 v108, v91, v87, s40
  v_perm_b32 v110, v91, v87, s41
  v_perm_b32 v109, v83, v95, s40
  v_perm_b32 v111, v83, v95, s41
  v_mov_b32 v225, v144
  v_mov_b32 v226, v148
  v_cmp_ne_u32 vcc, s32, v236
  s_nop 0
  s_cmp_eq_u64 vcc, 0
  s_cselect_b32 s33, s33, 0
L_hpoll:
  global_load_dwordx4 v[80:83], v249, s[26:27] sc1
  global_load_dwordx4 v[84:87], v249, s[26:27] offset:256 sc1
  s_sub_u32 s60, s60, 1
  s_cbranch_scc1 L_exit
  s_waitcnt vmcnt(1)
  v_perm_b32 v12, v81, v80, s38
  v_perm_b32 v13, v83, v82, s39
  v_or_b32 v12, v12, v13
  v_cmp_ne_u32 s[56:57], s37, v12
  v_perm_b32 v216, v81, v80, s41
  v_perm_b32 v217, v83, v82, s41
  s_waitcnt vmcnt(0)
  v_perm_b32 v218, v85, v84, s41
  v_perm_b32 v219, v87, v86, s41
  v_perm_b32 v12, v85, v84, s38
  v_perm_b32 v13, v87, v86, s39
  v_or_b32 v12, v12, v13
  v_cmp_ne_u32 vcc, s37, v12
  s_nop 0
  s_or_b64 vcc, vcc, s[56:57]
  s_cbranch_vccnz L_hpoll
  v_dot2_f32_bf16 v220, v216, v224, 0
  v_dot2_f32_bf16 v221, v216, v216, 0
  v_dot2_f32_bf16 v220, v217, v224, v220
  v_dot2_f32_bf16 v221, v217, v217, v221
  v_dot2_f32_bf16 v220, v218, v224, v220
  v_dot2_f32_bf16 v221, v218, v218, v221
  v_dot2_f32_bf16 v220, v219, v224, v220
  v_dot2_f32_bf16 v221, v219, v219, v221
  v_mfma_f32_16x16x32_bf16 v[144:147], v[216:219], v[16:19], 0
  v_mfma_f32_16x16x32_bf16 v[160:163], v[216:219], v[32:35], 0
  s_nop 0
  v_permlane16_swap_b32 v220, v221
  v_add_f32 v220, v220, v221
  v_mfma_f32_16x16x32_bf16 v[148:151], v[216:219], v[20:23], 0
  s_nop 0
  v_add_f32_dpp v220, v220, v220 row_ror:8 row_mask:0xf bank_mask:0xf
  v_mfma_f32_16x16x32_bf16 v[164:167], v[216:219], v[36:39], 0
  s_nop 0
  v_add_f32_dpp v220, v220, v220 row_ror:4 row_mask:0xf bank_mask:0xf
  v_mfma_f32_16x16x32_bf16 v[152:155], v[216:219], v[24:27], 0
  s_nop 0
  v_add_f32_dpp v220, v220, v220 row_ror:2 row_mask:0xf bank_mask:0xf
  v_mfma_f32_16x16x32_bf16 v[168:171], v[216:219], v[40:43], 0
  s_nop 0
  v_add_f32_dpp v220, v220, v220 row_ror:1 row_mask:0xf bank_mask:0xf
  v_mov_b32 v221, v220
  v_mfma_f32_16x16x32_bf16 v[156:159], v[216:219], v[28:31], 0
  s_nop 0
  v_permlane32_swap_b32 v220, v221
  v_add_f32 v220, v220, v221
  v_mul_f32 v12, 0x3b000000, v220
  v_mul_f32 v13, 0x3b000000, v220
  v_mfma_f32_16x16x32_bf16 v[172:175], v[216:219], v[44:47], 0
  v_add_f32 v220, v144, v149
  v_permlane16_swap_b32 v12, v13
  v_add_f32 v221, v160, v165
  v_cvt_pk_bf16_f32 v14, v12, v12
  v_add_f32 v220, v220, v154
  v_and_b32 v14, 0xffff0000, v14
  v_add_f32 v221, v221, v170
  v_add_f32 v220, v220, v159
  s_cmp_eq_u32 s33, 0
  v_fma_f32 v220, -v14, v225, v220
  v_fma_f32 v221, -v14, v226, v221
  v_add_f32 v221, v221, v175
  s_mov_b64 exec, s[98:99]
  v_perm_b32 v220, v220, s34, v5
  v_perm_b32 v221, v221, s34, v5
  s_cbranch_scc1 L_slow_e
  global_store_dwordx2 v250, v[220:221], s[26:27]
L_back_e:
  s_mov_b64 exec, -1
  v_fma_f32 v13, -v12, v12, v13
  v_max_f32 v13, 0, v13
  v_cvt_pk_bf16_f32 v14, v12, v13
  v_lshlrev_b32 v12, 16, v14
  v_and_b32 v13, 0xffff0000, v14
  v_add_f32 v13, 0x3727c5ac, v13
  v_cvt_pk_bf16_f32 v13, v13, v13
  v_and_b32 v13, 0xffff0000, v13
  v_sqrt_f32 v13, v13
  s_nop 0
  v_cvt_pk_bf16_f32 v13, v13, v13
  v_and_b32 v13, 0xffff0000, v13
  v_rcp_f32 v222, v13
L_epoll:
  global_load_dwordx4 v[176:179], v251, s[26:27] sc1
  s_sub_u32 s60, s60, 1
  s_cbranch_scc1 L_exit
  s_waitcnt vmcnt(0)
  v_perm_b32 v12, v177, v176, s38
  v_perm_b32 v13, v179, v178, s39
  v_or_b32 v12, v12, v13
  v_cmp_ne_u32 vcc, s34, v12
  v_and_b32 v80, 0xffffff00, v176
  v_and_b32 v81, 0xffffff00, v177
  v_and_b32 v82, 0xffffff00, v178
  v_and_b32 v83, 0xffffff00, v179
  s_cbranch_vccnz L_epoll
  v_pk_add_f32 v[14:15], v[80:81], v[82:83]
  s_nop 1
  v_add_f32_dpp v14, v14, v14 quad_perm:[1,0,3,2] row_mask:0xf bank_mask:0xf
  v_add_f32_dpp v15, v15, v15 quad_perm:[1,0,3,2] row_mask:0xf bank_mask:0xf
  v_pk_mul_f32 v[14:15], v[14:15], v[222:223] op_sel_hi:[1,0]
  v_cvt_pk_bf16_f32 v15, v14, v15
  v_lshlrev_b32 v14, 16, v15
  v_and_b32 v15, 0xffff0000, v15
  v_mul_f32 v12, 0xbfb8aa3b, v14
  v_exp_f32 v12, v12
  s_nop 0
  v_add_f32 v12, 1.0, v12
  v_rcp_f32 v12, v12
  s_nop 0
  v_mul_f32 v14, v14, v12
  v_cvt_pk_bf16_f32 v14, v14, v14
  v_and_b32 v14, 0xffff0000, v14
  v_mul_f32 v14, v14, v15
  v_cvt_pk_bf16_f32 v14, v14, v14
  s_nop 1
  v_mov_b32_dpp v15, v14 row_ror:12 row_mask:0xf bank_mask:0xf
  v_perm_b32 v216, v15, v14, s41
  s_nop 1
  v_mov_b32_dpp v217, v216 row_ror:8 row_mask:0xf bank_mask:0xf
  s_nop 1
  v_mfma_f32_16x16x16_bf16 v[144:147], v[216:217], v[96:97], 0
  v_mfma_f32_16x16x16_bf16 v[160:163], v[216:217], v[104:105], 0
  v_mfma_f32_16x16x16_bf16 v[148:151], v[216:217], v[98:99], 0
  v_mfma_f32_16x16x16_bf16 v[164:167], v[216:217], v[106:107], 0
  v_mfma_f32_16x16x16_bf16 v[152:155], v[216:217], v[100:101], 0
  v_mfma_f32_16x16x16_bf16 v[168:171], v[216:217], v[108:109], 0
  v_mfma_f32_16x16x16_bf16 v[156:159], v[216:217], v[102:103], 0
  v_mfma_f32_16x16x16_bf16 v[172:175], v[216:217], v[110:111], 0
  s_mov_b32 exec_hi, 0
  s_nop 0
  v_cndmask_b32 v80, v144, v160, s[50:51]
  s_nop 0
  v_cndmask_b32 v81, v148, v164, s[50:51]
  v_perm_b32 v80, v80, s34, v5
  v_cndmask_b32 v82, v152, v168, s[50:51]
  v_perm_b32 v81, v81, s34, v5
  v_cndmask_b32 v83, v156, v172, s[50:51]
  v_perm_b32 v82, v82, s34, v5
  v_perm_b32 v83, v83, s34, v5
  global_store_dwordx4 v252, v[80:83], s[26:27] sc1
  s_mov_b64 exec, -1
  s_branch L_exit
L_exit:
L_end:
  s_endpgm
L_helper:
  s_getpc_b64 s[62:63]
L_pc:
  s_sub_u32 s62, s62, L_pc-sequential_preLN__sliding_block_cached__swiglu_ffn__decode_kernel
  s_subb_u32 s63, s63, 0
  s_mul_i32 s54, s29, 512
  v_lshl_add_u32 v14, v0, 3, s54
  v_min_u32 v14, L_code_end-sequential_preLN__sliding_block_cached__swiglu_ffn__decode_kernel-4, v14
  global_load_dword v16, v14, s[62:63]
  s_waitcnt lgkmcnt(0)
  s_cmp_lt_u32 s29, 16
  s_cbranch_scc1 L_helper_l
  s_lshl_b32 s54, s28, 7
  s_add_u32 s54, s54, 4096
  v_and_b32 v12, 31, v0
  v_lshl_add_u32 v8, v12, 2, s54
  s_and_b32 s29, s29, 15
  s_lshl_b32 s54, s28, 13
  s_lshl_b32 s55, s29, 9
  s_add_u32 s54, s54, s55
  s_add_u32 s54, s54, 851968
  v_lshl_add_u32 v12, v0, 3, s54
  s_lshl_b32 s55, s29, 7
  s_lshl_b32 s54, s28, 16
  s_add_u32 s54, s54, s55
  s_add_u32 s54, s54, 65536
  v_lshrrev_b32 v13, 3, v0
  v_lshlrev_b32 v13, 11, v13
  v_and_b32 v14, 7, v0
  v_lshl_add_u32 v13, v14, 4, v13
  v_add_u32 v13, s54, v13
  s_lshl_b32 s54, s28, 11
  s_lshl_b32 s55, s29, 7
  s_add_u32 s54, s54, s55
  s_add_u32 s54, s54, 8192
  v_lshl_add_u32 v14, v3, 3, s54
  s_barrier
  global_load_dword v37, v8, s[26:27]
  global_load_dword v17, v12, s[26:27]
  global_load_dwordx4 v[20:23], v13, s[26:27]
  v_add_u32 v13, 0x4000, v13
  global_load_dwordx4 v[24:27], v13, s[26:27]
  v_add_u32 v13, 0x4000, v13
  global_load_dwordx4 v[28:31], v13, s[26:27]
  v_add_u32 v13, 0x4000, v13
  global_load_dwordx4 v[32:35], v13, s[26:27]
  global_load_dword v18, v14, s[26:27]
  s_endpgm
L_helper_l:
  v_mov_b32 v12, 917504
  s_barrier
  s_lshl_b32 s54, s28, 24
  s_add_u32 s54, s54, 0xF00000
  v_mov_b32 v15, s54
  global_load_dword v24, v15, s[6:7] nt
  global_load_dword v17, v12, s[26:27] sc1
  global_load_dword v25, v15, s[8:9] nt
  s_endpgm
L_slow_mll:
  global_store_dwordx4 v245, v[12:15], s[26:27] sc1
  s_branch L_back_mll
L_slow_a1l:
  global_store_dwordx2 v244, v[192:193], s[26:27] sc1
  s_branch L_back_a1l
L_slow_b1:
  global_store_dwordx4 v133, v[192:195], s[26:27] sc1
  s_branch L_back_b1
L_slow_b2b:
  global_store_dword v137, v81, s[26:27] sc1
  s_branch L_back_b2b
L_slow_mlh:
  global_store_dwordx4 v245, v[12:15], s[26:27] sc1
  s_branch L_back_mlh
L_slow_a1h:
  global_store_dwordx2 v244, v[192:193], s[26:27] sc1
  s_branch L_back_a1h
L_slow_e:
  global_store_dwordx2 v250, v[220:221], s[26:27] sc1
  s_branch L_back_e
L_code_end:
.section .rodata,"a"
.p2align 6
.amdhsa_kernel sequential_preLN__sliding_block_cached__swiglu_ffn__decode_kernel
  .amdhsa_next_free_vgpr 256
  .amdhsa_next_free_sgpr 102
  .amdhsa_accum_offset 256
  .amdhsa_group_segment_fixed_size 0
  .amdhsa_kernarg_size 96
  .amdhsa_user_sgpr_count 2
  .amdhsa_user_sgpr_kernarg_segment_ptr 1
  .amdhsa_system_sgpr_workgroup_id_x 1
.end_amdhsa_kernel
```
